```python
import torch

def _softmax(x, axis=-1):
    return torch.softmax(x, dim=axis)
def _gelu(x):
    return torch.nn.functional.gelu(x, approximate="tanh")
def _silu(x):
    return torch.nn.functional.silu(x)
def _sigmoid(x):
    return torch.sigmoid(x)
def _layernorm(x, axis=-1, eps=1e-5):
    m = x.mean(dim=axis, keepdim=True)
    v = x.var(dim=axis, keepdim=True, unbiased=False)
    return (x - m) / torch.sqrt(v + eps)
def _scatter_add(tgt, idx, src, axis=0):
    return tgt.clone().index_add_(axis, idx, src)
def _segment_sum(src, seg, n):
    out = torch.zeros((n,) + src.shape[1:], dtype=src.dtype)
    return out.index_add_(0, seg, src)
def _pad(x, pw):
    flat = tuple(v for pair in reversed(pw) for v in pair)
    return torch.nn.functional.pad(x, flat)

kernel_name = 'recurrent_scan__sliding_block_cached__geglu_ffn__decode'

def setup_inputs():

    _w = (lambda a: (lambda t: t.to(torch.bfloat16) if t.is_floating_point() else t)(torch.as_tensor(a)))
    def _A_setup():
        B, Sq, D = 2, 1, 576
        Hq, Hkv, Sk, Dh = 32, 16, 4096, 128
        assert Hq % Hkv == 0, (Hq, Hkv)
        return {
            "x": _w((lambda *s: torch.randn(*s, dtype=torch.bfloat16) * 0.05)(B, Sq, D)),
            "k_cache": _w((lambda *s: torch.randn(*s, dtype=torch.bfloat16) * 0.8)(B, Hkv, Sk, Dh)),
            "v_cache": _w((lambda *s: torch.randn(*s, dtype=torch.bfloat16) * 0.2)(B, Hkv, Sk, Dh)),
            "wq": _w((lambda *s: torch.randn(*s, dtype=torch.bfloat16) * 0.8)(D, Hq * Dh) * (D ** -0.5)),
            "wo": _w((lambda *s: torch.randn(*s, dtype=torch.bfloat16) * 0.2)(Hq * Dh, D) * ((Hq * Dh) ** -0.5)),
        }
    _A_in = _A_setup()

    def _B_setup():
        B, S, D, F = 2, 1, 576, 4608
        return {
            "x": _w((lambda *s: torch.randn(*s, dtype=torch.bfloat16) * 0.05)(B, S, D)),
            "w_gate": _w((lambda *s: torch.randn(*s, dtype=torch.bfloat16) * 0.1)(D, F)),
            "w_up": _w((lambda *s: torch.randn(*s, dtype=torch.bfloat16) * 0.1)(D, F)),
            "w_down": _w((lambda *s: torch.randn(*s, dtype=torch.bfloat16) * 0.1)(F, D)),
        }
    _B_in = _B_setup()

    return {
        "A_x": _A_in["x"],
        "A_k_cache": _A_in["k_cache"],
        "A_v_cache": _A_in["v_cache"],
        "A_wq": _A_in["wq"],
        "A_wo": _A_in["wo"],
        "B_x": _B_in["x"],
        "B_w_gate": _B_in["w_gate"],
        "B_w_up": _B_in["w_up"],
        "B_w_down": _B_in["w_down"],
    }

def reference(A_x, A_k_cache, A_v_cache, A_wq, A_wo, B_x, B_w_gate, B_w_up, B_w_down):
    def _A_ref(x, k_cache, v_cache, wq, wo):
        B, Sq, D = x.shape
        Hq, Dh = 32, 128
        Hkv, Sk = k_cache.shape[1], k_cache.shape[2]
        W = min(4096, max(256, Sk // 4))
        rep = Hq // Hkv
        q = (lambda x, *d: x.permute(*d))((x @ wq).reshape(B, Sq, Hq, Dh), 0, 2, 1, 3)
        k = (lambda x, n, axis: torch.repeat_interleave(x, n, dim=axis))(k_cache[:, :, Sk - W:, :], rep, axis=1)
        v = (lambda x, n, axis: torch.repeat_interleave(x, n, dim=axis))(v_cache[:, :, Sk - W:, :], rep, axis=1)
        scores = torch.einsum("bhqd,bhkd->bhqk", q, k) * (Dh ** -0.5)
        p = _softmax(scores, axis=-1)
        o = torch.einsum("bhqk,bhkd->bhqd", p, v)
        return (lambda x, *d: x.permute(*d))(o, 0, 2, 1, 3).reshape(B, Sq, Hq * Dh) @ wo

    def _B_ref(x, w_gate, w_up, w_down):
        return (_gelu(x @ w_gate) * (x @ w_up)) @ w_down

    x = A_x
    xn = _layernorm(x, axis=-1)
    s = _A_ref(xn, A_k_cache, A_v_cache, A_wq, A_wo)
    g = _silu(_B_ref(xn, B_w_gate, B_w_up, B_w_down))
    return x + s * g
```

```asm
; @launch grid=(256,1,1) block=(576,1,1) lds=151552
.amdgcn_target "amdgcn-amd-amdhsa--gfx950"
.text
.globl recurrent_scan__sliding_block_cached__geglu_ffn__decode_kernel
.p2align 8
.type recurrent_scan__sliding_block_cached__geglu_ffn__decode_kernel,@function
recurrent_scan__sliding_block_cached__geglu_ffn__decode_kernel:
    s_load_dwordx16 s[8:23], s[0:1], 0
    s_load_dwordx8 s[24:31], s[0:1], 64
    s_cmp_ge_u32 s2, 256
    s_cbranch_scc1 L_end
    s_getpc_b64 s[4:5]
L_pc:
    v_mul_u32_u24 v32, 36, v0
    v_min_u32 v32, L_code_end-L_pc-4, v32
    global_load_dword v18, v32, s[4:5]
    v_lshrrev_b32 v33, 6, v0
    v_bfe_u32 v2, v0, 4, 2
    v_readfirstlane_b32 s43, v33
    v_and_b32 v3, 15, v0
    s_and_b32 s46, s2, 7
    s_lshl_b32 s40, s46, 2
    s_bfe_u32 s60, s2, 0x20003
    s_or_b32 s40, s40, s60
    s_lshr_b32 s41, s2, 5
    s_add_u32 s42, s40, 4
    s_and_b32 s42, s42, 31
    v_mov_b32 v17, 0
    v_lshlrev_b32 v33, 2, v3
    ds_write_b32 v33, v17 offset:0
    s_cmp_lg_u32 s43, 0
    s_cbranch_scc1 L_stub
    s_mul_i32 s60, s41, 589824
    s_lshl_b32 s61, s42, 8
    s_add_u32 s60, s60, s61
    v_lshl_add_u32 v32, v3, 4, s60
    v_lshl_add_u32 v20, v2, 13, v32
    s_mov_b32 m0, 126976
    s_setprio 3
    s_waitcnt lgkmcnt(0)
    global_load_lds_dwordx4 v20, s[14:15] offset:0 sc1 nt
    s_addk_i32 m0, 1024
    v_add_u32 v20, 32768, v20
    global_load_lds_dwordx4 v20, s[14:15] offset:0 sc1 nt
    s_addk_i32 m0, 1024
    v_add_u32 v20, 32768, v20
    global_load_lds_dwordx4 v20, s[14:15] offset:0 sc1 nt
    s_addk_i32 m0, 1024
    v_add_u32 v20, 32768, v20
    global_load_lds_dwordx4 v20, s[14:15] offset:0 sc1 nt
    s_addk_i32 m0, 1024
    v_add_u32 v20, 32768, v20
    s_branch L_loader2
L_stub:
    v_and_b32 v4, 7, v0
    v_bfe_u32 v5, v0, 3, 1
    v_mul_u32_u24 v34, 1152, v5
    v_lshl_add_u32 v35, v2, 3, v4
    v_lshl_add_u32 v36, v35, 4, v34
    v_lshl_add_u32 v37, v35, 2, v34
    s_cmp_ge_u32 s43, 5
    s_waitcnt lgkmcnt(0)
    s_cbranch_scc1 L_stub_A
    global_load_dwordx4 v[44:47], v36, s[8:9]
    global_load_dwordx4 v[48:51], v36, s[8:9] offset:512
    global_load_dword v52, v37, s[8:9] offset:1024
    s_barrier
    s_branch L_role_X
L_stub_A:
    s_barrier
    s_branch L_role_A
L_loader2:
    global_load_lds_dwordx4 v20, s[14:15] offset:0 sc1 nt
    s_addk_i32 m0, 1024
    v_add_u32 v20, 32768, v20
    global_load_lds_dwordx4 v20, s[14:15] offset:0 sc1 nt
    s_addk_i32 m0, 1024
    v_add_u32 v20, 32768, v20
    global_load_lds_dwordx4 v20, s[14:15] offset:0 sc1 nt
    s_addk_i32 m0, 1024
    v_add_u32 v20, 32768, v20
    global_load_lds_dwordx4 v20, s[14:15] offset:0 sc1 nt
    s_addk_i32 m0, 1024
    v_add_u32 v20, 32768, v20
    global_load_lds_dwordx4 v20, s[14:15] offset:0 sc1 nt
    s_addk_i32 m0, 1024
    v_add_u32 v20, 32768, v20
    global_load_lds_dwordx4 v20, s[14:15] offset:0 sc1 nt
    s_addk_i32 m0, 1024
    v_add_u32 v20, 32768, v20
    s_barrier
    global_load_lds_dwordx4 v20, s[14:15] offset:0 sc1 nt
    s_addk_i32 m0, 1024
    v_add_u32 v20, 32768, v20
    global_load_lds_dwordx4 v20, s[14:15] offset:0 sc1 nt
    s_addk_i32 m0, 1024
    v_add_u32 v20, 32768, v20
    global_load_lds_dwordx4 v20, s[14:15] offset:0 sc1 nt
    s_addk_i32 m0, 1024
    v_add_u32 v20, 32768, v20
    global_load_lds_dwordx4 v20, s[14:15] offset:0 sc1 nt
    s_addk_i32 m0, 1024
    v_add_u32 v20, 32768, v20
    global_load_lds_dwordx4 v20, s[14:15] offset:0 sc1 nt
    s_addk_i32 m0, 1024
    v_add_u32 v20, 32768, v20
    global_load_lds_dwordx4 v20, s[14:15] offset:0 sc1 nt
    s_addk_i32 m0, 1024
    v_add_u32 v20, 32768, v20
    global_load_lds_dwordx4 v20, s[14:15] offset:0 sc1 nt
    s_addk_i32 m0, 1024
    v_add_u32 v20, 32768, v20
    global_load_lds_dwordx4 v20, s[14:15] offset:0 sc1 nt
    s_lshl_b32 s60, s2, 2
    s_add_u32 s60, s60, L_roles-L_pc
    s_load_dword s101, s[4:5], s60
    s_and_b32 s54, s40, 1
    s_lshl_b32 s54, s54, 24
    s_lshr_b32 s61, s40, 1
    s_lshl_b32 s61, s61, 20
    s_add_u32 s54, s54, s61
    s_add_u32 s54, s54, 786432
    v_bfe_u32 v32, v0, 2, 2
    v_lshl_add_u32 v21, v32, 14, s54
    v_and_b32 v32, 1, v0
    v_lshl_add_u32 v21, v32, 13, v21
    v_bfe_u32 v32, v0, 1, 1
    v_lshl_add_u32 v21, v32, 6, v21
    v_lshl_add_u32 v21, v2, 4, v21
    s_add_u32 s60, s41, s40
    s_add_u32 s60, s60, 0
    s_and_b32 s60, s60, 7
    s_lshl_b32 s60, s60, 3
    s_or_b32 s60, s60, s41
    s_and_b32 s61, s60, 15
    s_lshr_b32 s60, s60, 4
    s_lshl_b32 s60, s60, 16
    s_lshl_b32 s61, s61, 9
    s_or_b32 s60, s60, s61
    s_mov_b32 m0, 4096
    v_add_u32 v23, s60, v21
    global_load_lds_dwordx4 v23, s[10:11] offset:0 sc1 nt
    s_addk_i32 m0, 896
    s_nop 0
    global_load_lds_dwordx4 v23, s[10:11] offset:128 sc1 nt
    s_addk_i32 m0, 896
    s_nop 0
    global_load_lds_dwordx4 v23, s[10:11] offset:256 sc1 nt
    v_lshl_add_u32 v22, v2, 14, s54
    v_lshl_add_u32 v22, v3, 4, v22
    s_mov_b32 s63, 1048576
    s_lshr_b32 s45, s2, 3
    s_min_u32 s60, s45, 26
    s_mul_i32 s59, s46, 27
    s_add_u32 s59, s59, s60
    s_mul_i32 s57, s59, 171
    s_lshr_b32 s57, s57, 9
    s_mul_i32 s60, s57, 3
    s_sub_u32 s60, s59, s60
    s_mul_i32 s60, s60, 192
    v_mad_u32_u24 v32, v2, 48, s60
    v_mul_u32_u24 v32, 9216, v32
    s_lshl_b32 s61, s57, 7
    v_lshlrev_b32 v33, 4, v3
    v_xor_b32 v33, s61, v33
    v_add_u32 v32, v32, v33
    v_cmp_lt_u32 vcc, 7, v3
    v_mov_b32 v33, s20
    v_mov_b32 v34, s22
    v_cndmask_b32 v30, v33, v34, vcc
    v_mov_b32 v33, s21
    v_mov_b32 v34, s23
    v_cndmask_b32 v31, v33, v34, vcc
    v_add_co_u32 v30, vcc, v30, v32
    s_mov_b32 s64, 9216
    s_mov_b32 s65, 0
    v_addc_co_u32 v31, vcc, 0, v31, vcc
    s_addk_i32 m0, 896
    s_waitcnt vmcnt(20)
    global_load_lds_dwordx4 v23, s[10:11] offset:384 sc1 nt
    s_add_u32 s60, s41, s40
    s_add_u32 s60, s60, 1
    s_and_b32 s60, s60, 7
    s_lshl_b32 s60, s60, 3
    s_or_b32 s60, s60, s41
    s_and_b32 s61, s60, 15
    s_lshr_b32 s60, s60, 4
    s_lshl_b32 s60, s60, 16
    s_lshl_b32 s61, s61, 9
    s_or_b32 s60, s60, s61
    s_addk_i32 m0, 5504
    v_add_u32 v23, s60, v21
    s_waitcnt vmcnt(20)
    global_load_lds_dwordx4 v23, s[10:11] offset:0 sc1 nt
    s_addk_i32 m0, 896
    s_waitcnt vmcnt(20)
    global_load_lds_dwordx4 v23, s[10:11] offset:128 sc1 nt
    s_addk_i32 m0, 896
    s_waitcnt vmcnt(20)
    global_load_lds_dwordx4 v23, s[10:11] offset:256 sc1 nt
    s_addk_i32 m0, 896
    s_waitcnt vmcnt(20)
    global_load_lds_dwordx4 v23, s[10:11] offset:384 sc1 nt
    s_add_u32 s60, s41, s40
    s_add_u32 s60, s60, 2
    s_and_b32 s60, s60, 7
    s_lshl_b32 s60, s60, 3
    s_or_b32 s60, s60, s41
    s_and_b32 s61, s60, 15
    s_lshr_b32 s60, s60, 4
    s_lshl_b32 s60, s60, 16
    s_lshl_b32 s61, s61, 9
    s_or_b32 s60, s60, s61
    s_addk_i32 m0, 5504
    v_add_u32 v23, s60, v21
    s_waitcnt vmcnt(20)
    global_load_lds_dwordx4 v23, s[10:11] offset:0 sc1 nt
    s_addk_i32 m0, 896
    s_waitcnt vmcnt(20)
    global_load_lds_dwordx4 v23, s[10:11] offset:128 sc1 nt
    s_addk_i32 m0, 896
    s_waitcnt vmcnt(20)
    global_load_lds_dwordx4 v23, s[10:11] offset:256 sc1 nt
    s_addk_i32 m0, 896
    s_waitcnt vmcnt(20)
    global_load_lds_dwordx4 v23, s[10:11] offset:384 sc1 nt
    s_add_u32 s60, s41, s40
    s_add_u32 s60, s60, 3
    s_and_b32 s60, s60, 7
    s_lshl_b32 s60, s60, 3
    s_or_b32 s60, s60, s41
    s_and_b32 s61, s60, 15
    s_lshr_b32 s60, s60, 4
    s_lshl_b32 s60, s60, 16
    s_lshl_b32 s61, s61, 9
    s_or_b32 s60, s60, s61
    s_addk_i32 m0, 5504
    v_add_u32 v23, s60, v21
    s_waitcnt vmcnt(20)
    global_load_lds_dwordx4 v23, s[10:11] offset:0 sc1 nt
    s_addk_i32 m0, 896
    s_waitcnt vmcnt(20)
    global_load_lds_dwordx4 v23, s[10:11] offset:128 sc1 nt
    s_addk_i32 m0, 896
    s_waitcnt vmcnt(20)
    global_load_lds_dwordx4 v23, s[10:11] offset:256 sc1 nt
    s_addk_i32 m0, 896
    s_waitcnt vmcnt(20)
    global_load_lds_dwordx4 v23, s[10:11] offset:384 sc1 nt
    s_add_u32 s60, s41, s40
    s_add_u32 s60, s60, 4
    s_and_b32 s60, s60, 7
    s_lshl_b32 s60, s60, 3
    s_or_b32 s60, s60, s41
    s_and_b32 s61, s60, 15
    s_lshr_b32 s60, s60, 4
    s_lshl_b32 s60, s60, 16
    s_lshl_b32 s61, s61, 9
    s_or_b32 s60, s60, s61
    s_addk_i32 m0, -23168
    v_add_u32 v23, s60, v21
    s_waitcnt vmcnt(20)
    global_load_lds_dwordx4 v23, s[10:11] offset:0 sc1 nt
    s_addk_i32 m0, 896
    s_waitcnt vmcnt(20)
    global_load_lds_dwordx4 v23, s[10:11] offset:128 sc1 nt
    s_addk_i32 m0, 896
    s_waitcnt vmcnt(20)
    global_load_lds_dwordx4 v23, s[10:11] offset:256 sc1 nt
    s_addk_i32 m0, 896
    s_waitcnt vmcnt(20)
    global_load_lds_dwordx4 v23, s[10:11] offset:384 sc1 nt
    s_add_u32 s60, s41, s40
    s_add_u32 s60, s60, 5
    s_and_b32 s60, s60, 7
    s_lshl_b32 s60, s60, 3
    s_or_b32 s60, s60, s41
    s_and_b32 s61, s60, 15
    s_lshr_b32 s60, s60, 4
    s_lshl_b32 s60, s60, 16
    s_lshl_b32 s61, s61, 9
    s_or_b32 s60, s60, s61
    s_addk_i32 m0, 5504
    v_add_u32 v23, s60, v21
    s_waitcnt vmcnt(20)
    v_mov_b32 v28, 1
    ds_write_b32 v17, v28 offset:0
    global_load_lds_dwordx4 v23, s[10:11] offset:0 sc1 nt
    s_addk_i32 m0, 896
    s_waitcnt vmcnt(20)
    global_load_lds_dwordx4 v23, s[10:11] offset:128 sc1 nt
    s_addk_i32 m0, 896
    s_waitcnt vmcnt(20)
    global_load_lds_dwordx4 v23, s[10:11] offset:256 sc1 nt
    s_addk_i32 m0, 896
    s_waitcnt vmcnt(20)
    global_load_lds_dwordx4 v23, s[10:11] offset:384 sc1 nt
    s_add_u32 s60, s41, s40
    s_add_u32 s60, s60, 6
    s_and_b32 s60, s60, 7
    s_lshl_b32 s60, s60, 3
    s_or_b32 s60, s60, s41
    s_and_b32 s61, s60, 15
    s_lshr_b32 s60, s60, 4
    s_lshl_b32 s60, s60, 16
    s_lshl_b32 s61, s61, 9
    s_or_b32 s60, s60, s61
    s_addk_i32 m0, 5504
    v_add_u32 v23, s60, v21
    s_waitcnt vmcnt(20)
    global_load_lds_dwordx4 v23, s[10:11] offset:0 sc1 nt
    s_addk_i32 m0, 896
    s_waitcnt vmcnt(20)
    global_load_lds_dwordx4 v23, s[10:11] offset:128 sc1 nt
    s_addk_i32 m0, 896
    s_waitcnt vmcnt(20)
    global_load_lds_dwordx4 v23, s[10:11] offset:256 sc1 nt
    s_addk_i32 m0, 896
    s_waitcnt vmcnt(20)
    global_load_lds_dwordx4 v23, s[10:11] offset:384 sc1 nt
    s_add_u32 s60, s41, s40
    s_add_u32 s60, s60, 7
    s_and_b32 s60, s60, 7
    s_lshl_b32 s60, s60, 3
    s_or_b32 s60, s60, s41
    s_and_b32 s61, s60, 15
    s_lshr_b32 s60, s60, 4
    s_lshl_b32 s60, s60, 16
    s_lshl_b32 s61, s61, 9
    s_or_b32 s60, s60, s61
    s_addk_i32 m0, 5504
    v_add_u32 v23, s60, v21
    s_waitcnt vmcnt(20)
    global_load_lds_dwordx4 v23, s[10:11] offset:0 sc1 nt
    s_addk_i32 m0, 896
    s_waitcnt vmcnt(20)
    global_load_lds_dwordx4 v23, s[10:11] offset:128 sc1 nt
    s_addk_i32 m0, 896
    s_waitcnt vmcnt(20)
    global_load_lds_dwordx4 v23, s[10:11] offset:256 sc1 nt
    s_addk_i32 m0, 896
    s_waitcnt vmcnt(20)
    global_load_lds_dwordx4 v23, s[10:11] offset:384 sc1 nt
    s_waitcnt lgkmcnt(0)
    s_and_b32 s6, s101, 127
    s_bfe_u32 s58, s101, 0x20007
    s_mul_i32 s60, s6, 73728
    s_mul_i32 s61, s58, 384
    s_add_u32 s55, s60, s61
    v_lshrrev_b32 v32, 1, v2
    v_and_b32 v33, 1, v2
    v_lshl_add_u32 v32, v33, 1, v32
    v_mul_u32_u24 v32, 1152, v32
    v_lshl_add_u32 v25, v3, 4, v32
    v_add_u32 v25, s55, v25
    v_bfe_u32 v33, v0, 3, 1
    v_mul_u32_u24 v33, 4608, v33
    v_and_b32 v34, 7, v0
    v_lshl_add_u32 v32, v34, 4, v32
    v_add_u32 v32, v32, v33
    v_add_u32 v26, s55, v32
    s_bfe_u32 s7, s101, 0x60009
    s_bfe_u32 s56, s101, 0x4000f
    s_mul_i32 s61, s7, 73728
    s_lshl_b32 s60, s56, 7
    s_add_u32 s61, s61, s60
    v_add_u32 v27, s61, v32
    s_add_u32 s60, s41, s40
    s_add_u32 s60, s60, 0
    s_and_b32 s60, s60, 7
    s_lshl_b32 s60, s60, 3
    s_or_b32 s60, s60, s41
    s_and_b32 s61, s60, 15
    s_lshr_b32 s60, s60, 4
    s_lshl_b32 s60, s60, 16
    s_lshl_b32 s61, s61, 9
    s_or_b32 s60, s60, s61
    s_addk_i32 m0, 1408
    v_add_u32 v23, s60, v22
    v_add_u32 v20, 8192, v23
    s_waitcnt vmcnt(20)
    global_load_lds_dwordx4 v23, s[12:13] offset:0 sc1 nt
    s_addk_i32 m0, 1024
    s_waitcnt vmcnt(20)
    global_load_lds_dwordx4 v20, s[12:13] offset:0 sc1 nt
    s_addk_i32 m0, 768
    s_waitcnt vmcnt(20)
    global_load_lds_dwordx4 v23, s[12:13] offset:256 sc1 nt
    s_addk_i32 m0, 1024
    s_waitcnt vmcnt(20)
    global_load_lds_dwordx4 v20, s[12:13] offset:256 sc1 nt
    s_add_u32 s60, s41, s40
    s_add_u32 s60, s60, 1
    s_and_b32 s60, s60, 7
    s_lshl_b32 s60, s60, 3
    s_or_b32 s60, s60, s41
    s_and_b32 s61, s60, 15
    s_lshr_b32 s60, s60, 4
    s_lshl_b32 s60, s60, 16
    s_lshl_b32 s61, s61, 9
    s_or_b32 s60, s60, s61
    s_addk_i32 m0, 5376
    v_add_u32 v23, s60, v22
    v_add_u32 v20, 8192, v23
    s_waitcnt vmcnt(20)
    v_mov_b32 v28, 2
    ds_write_b32 v17, v28 offset:0
    global_load_lds_dwordx4 v23, s[12:13] offset:0 sc1 nt
    s_addk_i32 m0, 1024
    s_waitcnt vmcnt(20)
    global_load_lds_dwordx4 v20, s[12:13] offset:0 sc1 nt
    s_addk_i32 m0, 768
    s_waitcnt vmcnt(20)
    global_load_lds_dwordx4 v23, s[12:13] offset:256 sc1 nt
    s_addk_i32 m0, 1024
    s_waitcnt vmcnt(20)
    global_load_lds_dwordx4 v20, s[12:13] offset:256 sc1 nt
    s_add_u32 s60, s41, s40
    s_add_u32 s60, s60, 2
    s_and_b32 s60, s60, 7
    s_lshl_b32 s60, s60, 3
    s_or_b32 s60, s60, s41
    s_and_b32 s61, s60, 15
    s_lshr_b32 s60, s60, 4
    s_lshl_b32 s60, s60, 16
    s_lshl_b32 s61, s61, 9
    s_or_b32 s60, s60, s61
    s_addk_i32 m0, 5376
    v_add_u32 v23, s60, v22
    v_add_u32 v20, 8192, v23
    s_waitcnt vmcnt(20)
    global_load_lds_dwordx4 v23, s[12:13] offset:0 sc1 nt
    s_addk_i32 m0, 1024
    s_waitcnt vmcnt(20)
    global_load_lds_dwordx4 v20, s[12:13] offset:0 sc1 nt
    s_addk_i32 m0, 768
    s_waitcnt vmcnt(20)
    global_load_lds_dwordx4 v23, s[12:13] offset:256 sc1 nt
    s_addk_i32 m0, 1024
    s_waitcnt vmcnt(20)
    global_load_lds_dwordx4 v20, s[12:13] offset:256 sc1 nt
    s_add_u32 s60, s41, s40
    s_add_u32 s60, s60, 3
    s_and_b32 s60, s60, 7
    s_lshl_b32 s60, s60, 3
    s_or_b32 s60, s60, s41
    s_and_b32 s61, s60, 15
    s_lshr_b32 s60, s60, 4
    s_lshl_b32 s60, s60, 16
    s_lshl_b32 s61, s61, 9
    s_or_b32 s60, s60, s61
    s_addk_i32 m0, 5376
    v_add_u32 v23, s60, v22
    v_add_u32 v20, 8192, v23
    s_waitcnt vmcnt(20)
    global_load_lds_dwordx4 v23, s[12:13] offset:0 sc1 nt
    s_addk_i32 m0, 1024
    s_waitcnt vmcnt(20)
    global_load_lds_dwordx4 v20, s[12:13] offset:0 sc1 nt
    s_addk_i32 m0, 768
    s_waitcnt vmcnt(20)
    global_load_lds_dwordx4 v23, s[12:13] offset:256 sc1 nt
    s_addk_i32 m0, 1024
    s_waitcnt vmcnt(20)
    global_load_lds_dwordx4 v20, s[12:13] offset:256 sc1 nt
    s_add_u32 s60, s41, s40
    s_add_u32 s60, s60, 4
    s_and_b32 s60, s60, 7
    s_lshl_b32 s60, s60, 3
    s_or_b32 s60, s60, s41
    s_and_b32 s61, s60, 15
    s_lshr_b32 s60, s60, 4
    s_lshl_b32 s60, s60, 16
    s_lshl_b32 s61, s61, 9
    s_or_b32 s60, s60, s61
    s_addk_i32 m0, -23296
    v_add_u32 v23, s60, v22
    v_add_u32 v20, 8192, v23
    s_waitcnt vmcnt(20)
    global_load_lds_dwordx4 v23, s[12:13] offset:0 sc1 nt
    s_addk_i32 m0, 1024
    s_waitcnt vmcnt(20)
    global_load_lds_dwordx4 v20, s[12:13] offset:0 sc1 nt
    s_addk_i32 m0, 768
    s_waitcnt vmcnt(20)
    global_load_lds_dwordx4 v23, s[12:13] offset:256 sc1 nt
    s_addk_i32 m0, 1024
    s_waitcnt vmcnt(20)
    global_load_lds_dwordx4 v20, s[12:13] offset:256 sc1 nt
    s_add_u32 s60, s41, s40
    s_add_u32 s60, s60, 5
    s_and_b32 s60, s60, 7
    s_lshl_b32 s60, s60, 3
    s_or_b32 s60, s60, s41
    s_and_b32 s61, s60, 15
    s_lshr_b32 s60, s60, 4
    s_lshl_b32 s60, s60, 16
    s_lshl_b32 s61, s61, 9
    s_or_b32 s60, s60, s61
    s_addk_i32 m0, 5376
    v_add_u32 v23, s60, v22
    v_add_u32 v20, 8192, v23
    s_waitcnt vmcnt(20)
    v_mov_b32 v28, 3
    ds_write_b32 v17, v28 offset:0
    global_load_lds_dwordx4 v23, s[12:13] offset:0 sc1 nt
    s_addk_i32 m0, 1024
    s_waitcnt vmcnt(20)
    global_load_lds_dwordx4 v20, s[12:13] offset:0 sc1 nt
    s_addk_i32 m0, 768
    s_waitcnt vmcnt(20)
    global_load_lds_dwordx4 v23, s[12:13] offset:256 sc1 nt
    s_addk_i32 m0, 1024
    s_waitcnt vmcnt(20)
    global_load_lds_dwordx4 v20, s[12:13] offset:256 sc1 nt
    s_add_u32 s60, s41, s40
    s_add_u32 s60, s60, 6
    s_and_b32 s60, s60, 7
    s_lshl_b32 s60, s60, 3
    s_or_b32 s60, s60, s41
    s_and_b32 s61, s60, 15
    s_lshr_b32 s60, s60, 4
    s_lshl_b32 s60, s60, 16
    s_lshl_b32 s61, s61, 9
    s_or_b32 s60, s60, s61
    s_addk_i32 m0, 5376
    v_add_u32 v23, s60, v22
    v_add_u32 v20, 8192, v23
    s_waitcnt vmcnt(20)
    global_load_lds_dwordx4 v23, s[12:13] offset:0 sc1 nt
    s_addk_i32 m0, 1024
    s_waitcnt vmcnt(20)
    global_load_lds_dwordx4 v20, s[12:13] offset:0 sc1 nt
    s_addk_i32 m0, 768
    s_waitcnt vmcnt(20)
    global_load_lds_dwordx4 v23, s[12:13] offset:256 sc1 nt
    s_addk_i32 m0, 1024
    s_waitcnt vmcnt(20)
    global_load_lds_dwordx4 v20, s[12:13] offset:256 sc1 nt
    s_add_u32 s60, s41, s40
    s_add_u32 s60, s60, 7
    s_and_b32 s60, s60, 7
    s_lshl_b32 s60, s60, 3
    s_or_b32 s60, s60, s41
    s_and_b32 s61, s60, 15
    s_lshr_b32 s60, s60, 4
    s_lshl_b32 s60, s60, 16
    s_lshl_b32 s61, s61, 9
    s_or_b32 s60, s60, s61
    s_addk_i32 m0, 5376
    v_add_u32 v23, s60, v22
    v_add_u32 v20, 8192, v23
    s_waitcnt vmcnt(20)
    global_load_lds_dwordx4 v23, s[12:13] offset:0 sc1 nt
    s_addk_i32 m0, 1024
    s_waitcnt vmcnt(20)
    global_load_lds_dwordx4 v20, s[12:13] offset:0 sc1 nt
    s_addk_i32 m0, 768
    s_waitcnt vmcnt(20)
    global_load_lds_dwordx4 v23, s[12:13] offset:256 sc1 nt
    s_addk_i32 m0, 1024
    s_waitcnt vmcnt(20)
    global_load_lds_dwordx4 v20, s[12:13] offset:256 sc1 nt
    s_cmp_ge_u32 s45, 27
    s_cbranch_scc1 L_load_light
    s_addk_i32 m0, 9472
    s_waitcnt vmcnt(20)
    global_load_lds_dwordx4 v[30:31], off sc1 nt
    s_addk_i32 m0, 1024
    v_lshl_add_u64 v[30:31], s[64:65], 0, v[30:31]
    s_waitcnt vmcnt(20)
    global_load_lds_dwordx4 v[30:31], off sc1 nt
    s_addk_i32 m0, 1024
    v_lshl_add_u64 v[30:31], s[64:65], 0, v[30:31]
    s_waitcnt vmcnt(20)
    global_load_lds_dwordx4 v[30:31], off sc1 nt
    s_addk_i32 m0, 1024
    v_lshl_add_u64 v[30:31], s[64:65], 0, v[30:31]
    s_waitcnt vmcnt(20)
    global_load_lds_dwordx4 v[30:31], off sc1 nt
    s_mov_b32 s32, s30
    s_mov_b32 s33, s31
    s_mov_b32 s34, 1393664
    s_mov_b32 s35, 0x20000
    s_load_dword s49, s[32:33], 0
    v_mov_b32 v6, 0xff
    v_lshlrev_b32 v149, 4, v0
    v_add_u32 v149, 69632, v149
    s_lshl_b32 s66, s59, 10
    s_add_u32 s66, s66, 528384
    s_addk_i32 m0, 1024
    v_lshl_add_u64 v[30:31], s[64:65], 0, v[30:31]
    s_waitcnt vmcnt(20)
    v_mov_b32 v28, 4
    ds_write_b32 v17, v28 offset:0
    global_load_lds_dwordx4 v[30:31], off sc1 nt
    s_addk_i32 m0, 1024
    v_lshl_add_u64 v[30:31], s[64:65], 0, v[30:31]
    s_waitcnt vmcnt(20)
    global_load_lds_dwordx4 v[30:31], off sc1 nt
    s_addk_i32 m0, 1024
    v_lshl_add_u64 v[30:31], s[64:65], 0, v[30:31]
    s_waitcnt vmcnt(20)
    global_load_lds_dwordx4 v[30:31], off sc1 nt
    s_addk_i32 m0, 1024
    v_lshl_add_u64 v[30:31], s[64:65], 0, v[30:31]
    s_waitcnt vmcnt(20)
    global_load_lds_dwordx4 v[30:31], off sc1 nt
    s_addk_i32 m0, 1024
    v_lshl_add_u64 v[30:31], s[64:65], 0, v[30:31]
    s_waitcnt vmcnt(20)
    global_load_lds_dwordx4 v[30:31], off sc1 nt
    s_addk_i32 m0, 1024
    v_lshl_add_u64 v[30:31], s[64:65], 0, v[30:31]
    s_waitcnt vmcnt(20)
    global_load_lds_dwordx4 v[30:31], off sc1 nt
    s_addk_i32 m0, 1024
    v_lshl_add_u64 v[30:31], s[64:65], 0, v[30:31]
    s_waitcnt vmcnt(20)
    global_load_lds_dwordx4 v[30:31], off sc1 nt
    s_addk_i32 m0, 1024
    v_lshl_add_u64 v[30:31], s[64:65], 0, v[30:31]
    s_waitcnt vmcnt(20)
    global_load_lds_dwordx4 v[30:31], off sc1 nt
    s_addk_i32 m0, 1024
    v_lshl_add_u64 v[30:31], s[64:65], 0, v[30:31]
    s_waitcnt vmcnt(20)
    global_load_lds_dwordx4 v[30:31], off sc1 nt
    s_addk_i32 m0, 1024
    v_lshl_add_u64 v[30:31], s[64:65], 0, v[30:31]
    s_waitcnt vmcnt(20)
    global_load_lds_dwordx4 v[30:31], off sc1 nt
    s_addk_i32 m0, 1024
    v_lshl_add_u64 v[30:31], s[64:65], 0, v[30:31]
    s_waitcnt vmcnt(20)
    global_load_lds_dwordx4 v[30:31], off sc1 nt
    s_addk_i32 m0, 1024
    v_lshl_add_u64 v[30:31], s[64:65], 0, v[30:31]
    s_waitcnt vmcnt(20)
    global_load_lds_dwordx4 v[30:31], off sc1 nt
    s_addk_i32 m0, 1024
    v_lshl_add_u64 v[30:31], s[64:65], 0, v[30:31]
    s_waitcnt vmcnt(20)
    global_load_lds_dwordx4 v[30:31], off sc1 nt
    s_addk_i32 m0, 1024
    v_lshl_add_u64 v[30:31], s[64:65], 0, v[30:31]
    s_waitcnt vmcnt(20)
    global_load_lds_dwordx4 v[30:31], off sc1 nt
    s_addk_i32 m0, 1024
    v_lshl_add_u64 v[30:31], s[64:65], 0, v[30:31]
    s_waitcnt vmcnt(20)
    global_load_lds_dwordx4 v[30:31], off sc1 nt
    s_addk_i32 m0, 1024
    v_lshl_add_u64 v[30:31], s[64:65], 0, v[30:31]
    s_waitcnt vmcnt(20)
    global_load_lds_dwordx4 v[30:31], off sc1 nt
    s_addk_i32 m0, 1024
    v_lshl_add_u64 v[30:31], s[64:65], 0, v[30:31]
    s_waitcnt vmcnt(20)
    v_mov_b32 v28, 5
    ds_write_b32 v17, v28 offset:0
    global_load_lds_dwordx4 v[30:31], off sc1 nt
    s_addk_i32 m0, 1024
    v_lshl_add_u64 v[30:31], s[64:65], 0, v[30:31]
    s_waitcnt vmcnt(20)
    global_load_lds_dwordx4 v[30:31], off sc1 nt
    s_addk_i32 m0, 1024
    v_lshl_add_u64 v[30:31], s[64:65], 0, v[30:31]
    s_waitcnt vmcnt(20)
    global_load_lds_dwordx4 v[30:31], off sc1 nt
    s_addk_i32 m0, 1024
    v_lshl_add_u64 v[30:31], s[64:65], 0, v[30:31]
    s_waitcnt vmcnt(20)
    global_load_lds_dwordx4 v[30:31], off sc1 nt
L_lw_1:
    ds_read_b32 v32, v17 offset:32
    s_sub_u32 s63, s63, 1
    s_cbranch_scc1 L_end
    s_waitcnt lgkmcnt(0)
    v_readfirstlane_b32 s62, v32
    s_cmp_lt_u32 s62, 1
    s_cbranch_scc1 L_lw_1
    ds_read_b128 v[40:43], v149 offset:45056
    ds_read_b128 v[44:47], v149 offset:46080
    ds_read_b128 v[48:51], v149 offset:47104
    ds_read_b128 v[52:55], v149 offset:48128
    ds_read_b128 v[56:59], v149 offset:49152
    ds_read_b128 v[60:63], v149 offset:50176
    ds_read_b128 v[64:67], v149 offset:51200
    ds_read_b128 v[68:71], v149 offset:52224
    ds_read_b128 v[72:75], v149 offset:53248
    ds_read_b128 v[76:79], v149 offset:54272
    ds_read_b128 v[80:83], v149 offset:55296
    ds_read_b128 v[84:87], v149 offset:56320
    ds_read_b32 v148, v149 offset:2048
    s_lshr_b32 s50, s49, 0
    s_add_u32 s50, s50, 1
    s_and_b32 s50, s50, 0xff
    s_lshr_b32 s51, s49, 8
    s_add_u32 s51, s51, 1
    s_and_b32 s51, s51, 0xff
    s_lshr_b32 s52, s49, 16
    s_add_u32 s52, s52, 1
    s_and_b32 s52, s52, 0xff
    s_lshr_b32 s53, s49, 24
    s_add_u32 s53, s53, 1
    s_and_b32 s53, s53, 0xff
    s_addk_i32 m0, 1024
    v_lshl_add_u64 v[30:31], s[64:65], 0, v[30:31]
    s_waitcnt vmcnt(20)
    v_mov_b32 v28, 6
    ds_write_b32 v17, v28 offset:0
    global_load_lds_dwordx4 v[30:31], off sc1 nt
    s_addk_i32 m0, 1024
    v_lshl_add_u64 v[30:31], s[64:65], 0, v[30:31]
    s_waitcnt vmcnt(20)
    global_load_lds_dwordx4 v[30:31], off sc1 nt
    s_addk_i32 m0, 1024
    v_lshl_add_u64 v[30:31], s[64:65], 0, v[30:31]
    s_waitcnt vmcnt(20)
    global_load_lds_dwordx4 v[30:31], off sc1 nt
    s_addk_i32 m0, 1024
    v_lshl_add_u64 v[30:31], s[64:65], 0, v[30:31]
    s_waitcnt vmcnt(20)
    global_load_lds_dwordx4 v[30:31], off sc1 nt
    s_waitcnt lgkmcnt(0)
    s_addk_i32 m0, 1024
    v_lshl_add_u64 v[30:31], s[64:65], 0, v[30:31]
    s_waitcnt vmcnt(20)
    v_mov_b32 v28, 7
    ds_write_b32 v17, v28 offset:0
    global_load_lds_dwordx4 v[30:31], off sc1 nt
    s_addk_i32 m0, 1024
    v_lshl_add_u64 v[30:31], s[64:65], 0, v[30:31]
    s_waitcnt vmcnt(20)
    global_load_lds_dwordx4 v[30:31], off sc1 nt
    s_addk_i32 m0, 1024
    v_lshl_add_u64 v[30:31], s[64:65], 0, v[30:31]
    s_waitcnt vmcnt(20)
    global_load_lds_dwordx4 v[30:31], off sc1 nt
    s_addk_i32 m0, 1024
    v_lshl_add_u64 v[30:31], s[64:65], 0, v[30:31]
    s_waitcnt vmcnt(20)
    global_load_lds_dwordx4 v[30:31], off sc1 nt
    s_addk_i32 m0, 1024
    v_lshl_add_u64 v[30:31], s[64:65], 0, v[30:31]
    s_waitcnt vmcnt(20)
    v_mov_b32 v28, 8
    ds_write_b32 v17, v28 offset:0
    global_load_lds_dwordx4 v[30:31], off sc1 nt
    s_addk_i32 m0, 1024
    v_lshl_add_u64 v[30:31], s[64:65], 0, v[30:31]
    s_waitcnt vmcnt(20)
    global_load_lds_dwordx4 v[30:31], off sc1 nt
    s_addk_i32 m0, 1024
    v_lshl_add_u64 v[30:31], s[64:65], 0, v[30:31]
    s_waitcnt vmcnt(20)
    global_load_lds_dwordx4 v[30:31], off sc1 nt
    s_addk_i32 m0, 1024
    v_lshl_add_u64 v[30:31], s[64:65], 0, v[30:31]
    s_waitcnt vmcnt(20)
    global_load_lds_dwordx4 v[30:31], off sc1 nt
    v_lshl_add_u64 v[30:31], s[64:65], 0, v[30:31]
    s_waitcnt vmcnt(20)
    v_mov_b32 v28, 9
    ds_write_b32 v17, v28 offset:0
    global_load_dwordx4 v[88:91], v[30:31], off sc1 nt
    v_lshl_add_u64 v[30:31], s[64:65], 0, v[30:31]
    s_waitcnt vmcnt(20)
    global_load_dwordx4 v[92:95], v[30:31], off sc1 nt
    v_lshl_add_u64 v[30:31], s[64:65], 0, v[30:31]
    s_waitcnt vmcnt(20)
    global_load_dwordx4 v[96:99], v[30:31], off sc1 nt
    v_lshl_add_u64 v[30:31], s[64:65], 0, v[30:31]
    s_waitcnt vmcnt(20)
    global_load_dwordx4 v[100:103], v[30:31], off sc1 nt
    v_lshl_add_u64 v[30:31], s[64:65], 0, v[30:31]
    s_waitcnt vmcnt(20)
    v_mov_b32 v28, 10
    ds_write_b32 v17, v28 offset:0
    global_load_dwordx4 v[104:107], v[30:31], off sc1 nt
    v_lshl_add_u64 v[30:31], s[64:65], 0, v[30:31]
    s_waitcnt vmcnt(20)
    global_load_dwordx4 v[108:111], v[30:31], off sc1 nt
    v_lshl_add_u64 v[30:31], s[64:65], 0, v[30:31]
    s_waitcnt vmcnt(20)
    global_load_dwordx4 v[112:115], v[30:31], off sc1 nt
    v_lshl_add_u64 v[30:31], s[64:65], 0, v[30:31]
    s_waitcnt vmcnt(20)
    global_load_dwordx4 v[116:119], v[30:31], off sc1 nt
    v_lshl_add_u64 v[30:31], s[64:65], 0, v[30:31]
    s_waitcnt vmcnt(20)
    v_mov_b32 v28, 11
    ds_write_b32 v17, v28 offset:0
    global_load_dwordx4 v[120:123], v[30:31], off sc1 nt
    v_lshl_add_u64 v[30:31], s[64:65], 0, v[30:31]
    s_waitcnt vmcnt(20)
    global_load_dwordx4 v[124:127], v[30:31], off sc1 nt
    v_lshl_add_u64 v[30:31], s[64:65], 0, v[30:31]
    s_waitcnt vmcnt(20)
    global_load_dwordx4 v[128:131], v[30:31], off sc1 nt
    v_lshl_add_u64 v[30:31], s[64:65], 0, v[30:31]
    s_waitcnt vmcnt(20)
    global_load_dwordx4 v[132:135], v[30:31], off sc1 nt
L_lw_2:
    ds_read_b32 v32, v17 offset:24
    s_sub_u32 s63, s63, 1
    s_cbranch_scc1 L_end
    s_waitcnt lgkmcnt(0)
    v_readfirstlane_b32 s62, v32
    s_cmp_lt_u32 s62, 1
    s_cbranch_scc1 L_lw_2
    s_addk_i32 m0, 13312
    s_waitcnt vmcnt(19)
    v_mov_b32 v28, 12
    ds_write_b32 v17, v28 offset:0
    global_load_lds_dwordx4 v25, s[24:25] offset:0 sc1 nt
    s_addk_i32 m0, 1024
    v_add_u32 v25, 18432, v25
    s_waitcnt vmcnt(19)
    global_load_lds_dwordx4 v25, s[24:25] offset:0 sc1 nt
    s_addk_i32 m0, 1024
    v_add_u32 v25, 18432, v25
    s_waitcnt vmcnt(19)
    global_load_lds_dwordx4 v25, s[24:25] offset:0 sc1 nt
    s_addk_i32 m0, 1024
    v_add_u32 v25, 18432, v25
    s_waitcnt vmcnt(19)
    v_mov_b32 v28, 13
    ds_write_b32 v17, v28 offset:0
    global_load_lds_dwordx4 v25, s[24:25] offset:0 sc1 nt
    s_addk_i32 m0, 13056
    s_waitcnt vmcnt(19)
    global_load_lds_dwordx4 v26, s[24:25] offset:256 sc1 nt
    s_addk_i32 m0, 1024
    v_add_u32 v26, 18432, v26
    s_waitcnt vmcnt(19)
    global_load_lds_dwordx4 v26, s[24:25] offset:256 sc1 nt
    s_addk_i32 m0, 1024
    v_add_u32 v26, 18432, v26
    s_waitcnt vmcnt(19)
    global_load_lds_dwordx4 v26, s[24:25] offset:256 sc1 nt
    s_addk_i32 m0, 1024
    v_add_u32 v26, 18432, v26
    s_waitcnt vmcnt(19)
    v_mov_b32 v28, 14
    ds_write_b32 v17, v28 offset:0
    global_load_lds_dwordx4 v26, s[24:25] offset:256 sc1 nt
    s_addk_i32 m0, -15104
    v_add_u32 v25, 4294916608, v25
    s_waitcnt vmcnt(19)
    v_mfma_f32_16x16x32_bf16 v[136:139], v[40:43], v[88:91], 0
    global_load_lds_dwordx4 v25, s[24:25] offset:0 sc1 nt
    s_addk_i32 m0, 1024
    v_add_u32 v25, 18432, v25
    s_waitcnt vmcnt(19)
    v_mfma_f32_16x16x32_bf16 v[136:139], v[44:47], v[92:95], v[136:139]
    global_load_lds_dwordx4 v25, s[24:25] offset:0 sc1 nt
    s_addk_i32 m0, 1024
    v_add_u32 v25, 18432, v25
    s_waitcnt vmcnt(19)
    v_mfma_f32_16x16x32_bf16 v[136:139], v[48:51], v[96:99], v[136:139]
    global_load_lds_dwordx4 v25, s[24:25] offset:0 sc1 nt
    s_addk_i32 m0, 1024
    v_add_u32 v25, 18432, v25
    s_waitcnt vmcnt(19)
    v_mfma_f32_16x16x32_bf16 v[136:139], v[52:55], v[100:103], v[136:139]
    v_mov_b32 v28, 15
    ds_write_b32 v17, v28 offset:0
    global_load_lds_dwordx4 v25, s[24:25] offset:0 sc1 nt
    s_addk_i32 m0, 1024
    v_add_u32 v25, 4294916608, v25
    s_waitcnt vmcnt(19)
    v_mfma_f32_16x16x32_bf16 v[136:139], v[56:59], v[104:107], v[136:139]
    global_load_lds_dwordx4 v25, s[24:25] offset:0 sc1 nt
    s_addk_i32 m0, 1024
    v_add_u32 v25, 18432, v25
    s_waitcnt vmcnt(19)
    v_mfma_f32_16x16x32_bf16 v[136:139], v[60:63], v[108:111], v[136:139]
    global_load_lds_dwordx4 v25, s[24:25] offset:0 sc1 nt
    s_addk_i32 m0, 1024
    v_add_u32 v25, 18432, v25
    s_waitcnt vmcnt(19)
    v_mfma_f32_16x16x32_bf16 v[136:139], v[64:67], v[112:115], v[136:139]
    global_load_lds_dwordx4 v25, s[24:25] offset:0 sc1 nt
    s_addk_i32 m0, 1024
    v_add_u32 v25, 18432, v25
    s_waitcnt vmcnt(19)
    v_mfma_f32_16x16x32_bf16 v[136:139], v[68:71], v[116:119], v[136:139]
    v_mov_b32 v28, 16
    ds_write_b32 v17, v28 offset:0
    global_load_lds_dwordx4 v25, s[24:25] offset:0 sc1 nt
    s_addk_i32 m0, 8960
    v_add_u32 v26, 4294921216, v26
    s_waitcnt vmcnt(19)
    v_mfma_f32_16x16x32_bf16 v[136:139], v[72:75], v[120:123], v[136:139]
    global_load_lds_dwordx4 v26, s[24:25] offset:256 sc1 nt
    s_addk_i32 m0, 1024
    v_add_u32 v26, 18432, v26
    s_waitcnt vmcnt(19)
    v_mfma_f32_16x16x32_bf16 v[136:139], v[76:79], v[124:127], v[136:139]
    v_mov_b32 v28, 17
    ds_write_b32 v17, v28 offset:0
    global_load_lds_dwordx4 v26, s[24:25] offset:256 sc1 nt
    s_addk_i32 m0, 1024
    s_nop 3
L_lw_3:
    ds_read_b32 v32, v17 offset:36
    ds_read_b128 v[140:143], v149 offset:0
    ds_read_b128 v[144:147], v149 offset:1024
    s_sub_u32 s63, s63, 1
    s_cbranch_scc1 L_end
    s_waitcnt lgkmcnt(0)
    v_readfirstlane_b32 s62, v32
    s_cmp_lt_u32 s62, 2
    s_cbranch_scc1 L_lw_3
    v_pk_add_f32 v[136:137], v[136:137], v[140:141]
    v_pk_add_f32 v[138:139], v[138:139], v[142:143]
    v_pk_add_f32 v[136:137], v[136:137], v[144:145]
    v_pk_add_f32 v[138:139], v[138:139], v[146:147]
    v_add_u32 v26, 18432, v26
    s_waitcnt vmcnt(19)
    v_mfma_f32_16x16x32_bf16 v[136:139], v[80:83], v[128:131], v[136:139]
    global_load_lds_dwordx4 v26, s[24:25] offset:256 sc1 nt
    s_addk_i32 m0, 1024
    v_add_u32 v26, 18432, v26
    s_waitcnt vmcnt(19)
    v_mfma_f32_16x16x32_bf16 v[136:139], v[84:87], v[132:135], v[136:139]
    s_nop 7
    v_bfi_b32 v136, v6, s50, v136
    v_bfi_b32 v137, v6, s51, v137
    v_bfi_b32 v138, v6, s52, v138
    v_bfi_b32 v139, v6, s53, v139
    buffer_store_dwordx4 v[136:139], v148, s[32:35], s66 offen sc1
    v_mov_b32 v28, 18
    ds_write_b32 v17, v28 offset:0
    global_load_lds_dwordx4 v26, s[24:25] offset:256 sc1 nt
    s_addk_i32 m0, -11008
    v_add_u32 v25, 4294916608, v25
    s_waitcnt vmcnt(19)
    global_load_lds_dwordx4 v25, s[24:25] offset:0 sc1 nt
    s_addk_i32 m0, 1024
    v_add_u32 v25, 18432, v25
    s_waitcnt vmcnt(19)
    global_load_lds_dwordx4 v25, s[24:25] offset:0 sc1 nt
    s_addk_i32 m0, 1024
    v_add_u32 v25, 18432, v25
    s_waitcnt vmcnt(19)
    global_load_lds_dwordx4 v25, s[24:25] offset:0 sc1 nt
    s_addk_i32 m0, 1024
    v_add_u32 v25, 18432, v25
    s_waitcnt vmcnt(19)
    v_mov_b32 v28, 20
    ds_write_b32 v17, v28 offset:0
    global_load_lds_dwordx4 v25, s[24:25] offset:0 sc1 nt
    s_waitcnt vmcnt(12)
    v_mov_b32 v28, 21
    ds_write_b32 v17, v28 offset:0
    s_waitcnt vmcnt(9)
    v_mov_b32 v28, 22
    ds_write_b32 v17, v28 offset:0
    s_waitcnt vmcnt(0)
    v_mov_b32 v28, 23
    ds_write_b32 v17, v28 offset:0
    s_endpgm
L_load_light:
    s_bfe_u32 s7, s101, 0x60009
    s_mul_i32 s60, s7, 73728
    v_lshl_add_u32 v23, v0, 4, s60
    s_nop 1
L_lw_4:
    ds_read_b32 v32, v17 offset:24
    s_sub_u32 s63, s63, 1
    s_cbranch_scc1 L_end
    s_waitcnt lgkmcnt(0)
    v_readfirstlane_b32 s62, v32
    s_cmp_lt_u32 s62, 1
    s_cbranch_scc1 L_lw_4
    s_addk_i32 m0, 9472
    s_waitcnt vmcnt(19)
    global_load_lds_dwordx4 v23, s[16:17] offset:0 sc1 nt
    s_waitcnt vmcnt(19)
    global_load_lds_dwordx4 v23, s[16:17] offset:1024 sc1 nt
    s_waitcnt vmcnt(19)
    global_load_lds_dwordx4 v23, s[16:17] offset:2048 sc1 nt
    s_waitcnt vmcnt(19)
    v_mov_b32 v28, 4
    ds_write_b32 v17, v28 offset:0
    global_load_lds_dwordx4 v23, s[16:17] offset:3072 sc1 nt
    s_addk_i32 m0, 4096
    v_add_u32 v23, 4096, v23
    s_waitcnt vmcnt(19)
    global_load_lds_dwordx4 v23, s[16:17] offset:0 sc1 nt
    s_waitcnt vmcnt(19)
    global_load_lds_dwordx4 v23, s[16:17] offset:1024 sc1 nt
    s_waitcnt vmcnt(19)
    global_load_lds_dwordx4 v23, s[16:17] offset:2048 sc1 nt
    s_waitcnt vmcnt(19)
    global_load_lds_dwordx4 v23, s[16:17] offset:3072 sc1 nt
    s_addk_i32 m0, 4096
    v_add_u32 v23, 4096, v23
    s_waitcnt vmcnt(19)
    global_load_lds_dwordx4 v23, s[16:17] offset:0 sc1 nt
    s_addk_i32 m0, 10240
    v_add_u32 v23, 10240, v23
    s_waitcnt vmcnt(19)
    global_load_lds_dwordx4 v23, s[16:17] offset:0 sc1 nt
    s_waitcnt vmcnt(19)
    global_load_lds_dwordx4 v23, s[16:17] offset:1024 sc1 nt
    s_waitcnt vmcnt(19)
    global_load_lds_dwordx4 v23, s[16:17] offset:2048 sc1 nt
    s_waitcnt vmcnt(19)
    global_load_lds_dwordx4 v23, s[16:17] offset:3072 sc1 nt
    s_addk_i32 m0, 4096
    v_add_u32 v23, 4096, v23
    s_waitcnt vmcnt(19)
    global_load_lds_dwordx4 v23, s[16:17] offset:0 sc1 nt
    s_waitcnt vmcnt(19)
    global_load_lds_dwordx4 v23, s[16:17] offset:1024 sc1 nt
    s_waitcnt vmcnt(19)
    global_load_lds_dwordx4 v23, s[16:17] offset:2048 sc1 nt
    s_waitcnt vmcnt(19)
    global_load_lds_dwordx4 v23, s[16:17] offset:3072 sc1 nt
    s_addk_i32 m0, 4096
    v_add_u32 v23, 4096, v23
    s_waitcnt vmcnt(19)
    global_load_lds_dwordx4 v23, s[16:17] offset:0 sc1 nt
    s_addk_i32 m0, 10240
    v_add_u32 v23, 10240, v23
    s_waitcnt vmcnt(19)
    global_load_lds_dwordx4 v23, s[16:17] offset:0 sc1 nt
    s_waitcnt vmcnt(19)
    v_mov_b32 v28, 5
    ds_write_b32 v17, v28 offset:0
    global_load_lds_dwordx4 v23, s[16:17] offset:1024 sc1 nt
    s_waitcnt vmcnt(19)
    global_load_lds_dwordx4 v23, s[16:17] offset:2048 sc1 nt
    s_waitcnt vmcnt(19)
    global_load_lds_dwordx4 v23, s[16:17] offset:3072 sc1 nt
    s_addk_i32 m0, 4096
    v_add_u32 v23, 4096, v23
    s_waitcnt vmcnt(19)
    global_load_lds_dwordx4 v23, s[16:17] offset:0 sc1 nt
    s_waitcnt vmcnt(19)
    v_mov_b32 v28, 6
    ds_write_b32 v17, v28 offset:0
    global_load_lds_dwordx4 v23, s[16:17] offset:1024 sc1 nt
    s_waitcnt vmcnt(19)
    global_load_lds_dwordx4 v23, s[16:17] offset:2048 sc1 nt
    s_waitcnt vmcnt(19)
    global_load_lds_dwordx4 v23, s[16:17] offset:3072 sc1 nt
    s_addk_i32 m0, 4096
    v_add_u32 v23, 4096, v23
    s_waitcnt vmcnt(19)
    global_load_lds_dwordx4 v23, s[16:17] offset:0 sc1 nt
    s_addk_i32 m0, 10240
    v_add_u32 v23, 10240, v23
    s_waitcnt vmcnt(19)
    v_mov_b32 v28, 7
    ds_write_b32 v17, v28 offset:0
    global_load_lds_dwordx4 v23, s[16:17] offset:0 sc1 nt
    s_waitcnt vmcnt(19)
    global_load_lds_dwordx4 v23, s[16:17] offset:1024 sc1 nt
    s_waitcnt vmcnt(19)
    global_load_lds_dwordx4 v23, s[16:17] offset:2048 sc1 nt
    s_waitcnt vmcnt(19)
    global_load_lds_dwordx4 v23, s[16:17] offset:3072 sc1 nt
    s_addk_i32 m0, 4096
    v_add_u32 v23, 4096, v23
    s_waitcnt vmcnt(19)
    v_mov_b32 v28, 8
    ds_write_b32 v17, v28 offset:0
    global_load_lds_dwordx4 v23, s[16:17] offset:0 sc1 nt
    s_waitcnt vmcnt(19)
    global_load_lds_dwordx4 v23, s[16:17] offset:1024 sc1 nt
    s_waitcnt vmcnt(19)
    global_load_lds_dwordx4 v23, s[16:17] offset:2048 sc1 nt
    s_waitcnt vmcnt(19)
    global_load_lds_dwordx4 v23, s[16:17] offset:3072 sc1 nt
    s_addk_i32 m0, 4096
    v_add_u32 v23, 4096, v23
    s_waitcnt vmcnt(19)
    v_mov_b32 v28, 9
    ds_write_b32 v17, v28 offset:0
    global_load_lds_dwordx4 v23, s[16:17] offset:0 sc1 nt
    s_mov_b32 m0, 87040
    v_add_u32 v23, 4294913024, v23
    s_waitcnt vmcnt(19)
    global_load_lds_dwordx4 v23, s[16:17] offset:0 sc1 nt
    s_waitcnt vmcnt(19)
    global_load_lds_dwordx4 v23, s[16:17] offset:1024 sc1 nt
    s_waitcnt vmcnt(19)
    global_load_lds_dwordx4 v23, s[16:17] offset:2048 sc1 nt
    s_waitcnt vmcnt(19)
    v_mov_b32 v28, 10
    ds_write_b32 v17, v28 offset:0
    global_load_lds_dwordx4 v23, s[16:17] offset:3072 sc1 nt
    s_addk_i32 m0, 4096
    v_add_u32 v23, 4096, v23
    s_waitcnt vmcnt(19)
    global_load_lds_dwordx4 v23, s[16:17] offset:0 sc1 nt
    s_waitcnt vmcnt(19)
    global_load_lds_dwordx4 v23, s[16:17] offset:1024 sc1 nt
    s_waitcnt vmcnt(19)
    global_load_lds_dwordx4 v23, s[16:17] offset:2048 sc1 nt
    s_waitcnt vmcnt(19)
    v_mov_b32 v28, 11
    ds_write_b32 v17, v28 offset:0
    global_load_lds_dwordx4 v23, s[16:17] offset:3072 sc1 nt
    s_addk_i32 m0, 4096
    v_add_u32 v23, 4096, v23
    s_waitcnt vmcnt(19)
    global_load_lds_dwordx4 v23, s[16:17] offset:0 sc1 nt
    s_addk_i32 m0, 10240
    v_add_u32 v23, 10240, v23
    s_waitcnt vmcnt(19)
    global_load_lds_dwordx4 v23, s[16:17] offset:0 sc1 nt
    s_waitcnt vmcnt(19)
    global_load_lds_dwordx4 v23, s[16:17] offset:1024 sc1 nt
    s_waitcnt vmcnt(19)
    v_mov_b32 v28, 12
    ds_write_b32 v17, v28 offset:0
    global_load_lds_dwordx4 v23, s[16:17] offset:2048 sc1 nt
    s_waitcnt vmcnt(19)
    global_load_lds_dwordx4 v23, s[16:17] offset:3072 sc1 nt
    s_addk_i32 m0, 4096
    v_add_u32 v23, 4096, v23
    s_waitcnt vmcnt(19)
    global_load_lds_dwordx4 v23, s[16:17] offset:0 sc1 nt
    s_waitcnt vmcnt(19)
    global_load_lds_dwordx4 v23, s[16:17] offset:1024 sc1 nt
    s_waitcnt vmcnt(19)
    v_mov_b32 v28, 13
    ds_write_b32 v17, v28 offset:0
    global_load_lds_dwordx4 v23, s[16:17] offset:2048 sc1 nt
    s_waitcnt vmcnt(19)
    global_load_lds_dwordx4 v23, s[16:17] offset:3072 sc1 nt
    s_addk_i32 m0, 4096
    v_add_u32 v23, 4096, v23
    s_waitcnt vmcnt(19)
    global_load_lds_dwordx4 v23, s[16:17] offset:0 sc1 nt
    s_addk_i32 m0, 10240
    v_add_u32 v23, 10240, v23
    s_waitcnt vmcnt(19)
    global_load_lds_dwordx4 v23, s[16:17] offset:0 sc1 nt
    s_waitcnt vmcnt(19)
    v_mov_b32 v28, 14
    ds_write_b32 v17, v28 offset:0
    global_load_lds_dwordx4 v23, s[16:17] offset:1024 sc1 nt
    s_waitcnt vmcnt(19)
    global_load_lds_dwordx4 v23, s[16:17] offset:2048 sc1 nt
    s_waitcnt vmcnt(19)
    global_load_lds_dwordx4 v23, s[16:17] offset:3072 sc1 nt
    s_addk_i32 m0, 4096
    v_add_u32 v23, 4096, v23
    s_waitcnt vmcnt(19)
    global_load_lds_dwordx4 v23, s[16:17] offset:0 sc1 nt
    s_waitcnt vmcnt(19)
    v_mov_b32 v28, 15
    ds_write_b32 v17, v28 offset:0
    global_load_lds_dwordx4 v23, s[16:17] offset:1024 sc1 nt
    s_waitcnt vmcnt(19)
    global_load_lds_dwordx4 v23, s[16:17] offset:2048 sc1 nt
    s_waitcnt vmcnt(19)
    global_load_lds_dwordx4 v23, s[16:17] offset:3072 sc1 nt
    s_addk_i32 m0, 4096
    v_add_u32 v23, 4096, v23
    s_waitcnt vmcnt(19)
    global_load_lds_dwordx4 v23, s[16:17] offset:0 sc1 nt
    s_addk_i32 m0, 10240
    v_add_u32 v23, 10240, v23
    s_waitcnt vmcnt(19)
    v_mov_b32 v28, 16
    ds_write_b32 v17, v28 offset:0
    global_load_lds_dwordx4 v23, s[16:17] offset:0 sc1 nt
    s_waitcnt vmcnt(19)
    global_load_lds_dwordx4 v23, s[16:17] offset:1024 sc1 nt
    s_waitcnt vmcnt(19)
    global_load_lds_dwordx4 v23, s[16:17] offset:2048 sc1 nt
    s_waitcnt vmcnt(19)
    global_load_lds_dwordx4 v23, s[16:17] offset:3072 sc1 nt
    s_addk_i32 m0, 4096
    v_add_u32 v23, 4096, v23
    s_waitcnt vmcnt(19)
    v_mov_b32 v28, 17
    ds_write_b32 v17, v28 offset:0
    global_load_lds_dwordx4 v23, s[16:17] offset:0 sc1 nt
    s_waitcnt vmcnt(19)
    global_load_lds_dwordx4 v23, s[16:17] offset:1024 sc1 nt
    s_waitcnt vmcnt(19)
    global_load_lds_dwordx4 v23, s[16:17] offset:2048 sc1 nt
    s_waitcnt vmcnt(19)
    global_load_lds_dwordx4 v23, s[16:17] offset:3072 sc1 nt
    s_addk_i32 m0, 4096
    v_add_u32 v23, 4096, v23
    s_waitcnt vmcnt(19)
    v_mov_b32 v28, 18
    ds_write_b32 v17, v28 offset:0
    global_load_lds_dwordx4 v23, s[16:17] offset:0 sc1 nt
    s_waitcnt vmcnt(16)
    v_mov_b32 v28, 19
    ds_write_b32 v17, v28 offset:0
    s_waitcnt vmcnt(12)
    v_mov_b32 v28, 20
    ds_write_b32 v17, v28 offset:0
    s_waitcnt vmcnt(8)
    v_mov_b32 v28, 21
    ds_write_b32 v17, v28 offset:0
    s_waitcnt vmcnt(4)
    v_mov_b32 v28, 22
    ds_write_b32 v17, v28 offset:0
    s_waitcnt vmcnt(0)
    v_mov_b32 v28, 23
    ds_write_b32 v17, v28 offset:0
    s_endpgm
L_role_X:
    s_sub_u32 s44, s43, 1
    s_mul_i32 s60, s41, 144
    s_lshl_b32 s61, s44, 3
    s_add_u32 s61, s61, s60
    v_lshl_add_u32 v38, v2, 1, v34
    v_add_u32 v38, s61, v38
    s_and_b32 s61, s44, 1
    s_lshl_b32 s61, s61, 3
    s_add_u32 s61, s61, s60
    v_lshl_add_u32 v39, v2, 1, v34
    v_add_u32 v39, s61, v39
    s_lshr_b32 s45, s2, 3
    s_min_u32 s60, s45, 26
    s_mul_i32 s59, s46, 27
    s_add_u32 s59, s59, s60
    s_mul_i32 s57, s59, 171
    s_lshr_b32 s57, s57, 9
    s_mul_i32 s60, s57, 3
    s_sub_u32 s60, s59, s60
    s_mul_i32 s60, s60, 192
    v_mad_u32_u24 v40, v2, 48, s60
    v_lshl_add_u32 v74, v40, 1, v34
    s_mov_b32 s68, 0x3f803f80
    s_mov_b32 s32, s30
    s_mov_b32 s33, s31
    s_mov_b32 s34, 1393664
    s_mov_b32 s35, 0x20000
    s_load_dword s49, s[32:33], 0
    s_lshl_b32 s60, s2, 2
    s_add_u32 s60, s60, L_roles-L_pc
    s_load_dword s101, s[4:5], s60
    s_mov_b32 s69, 0xffff0000
    s_mov_b32 s63, 1048576
    s_lshr_b32 s45, s2, 3
    v_and_b32 v1, 63, v0
    v_mov_b32 v6, 0xff
    v_mov_b32 v16, 1
    v_lshlrev_b32 v7, 4, v1
    v_and_b32 v32, 1, v0
    v_lshlrev_b32 v32, 4, v32
    v_mov_b32 v33, 0xffff
    v_lshlrev_b32 v32, v32, v33
    v_lshrrev_b32 v33, 1, v4
    v_cmp_eq_u32 s[96:97], 0, v33
    v_cmp_eq_u32 s[98:99], 1, v33
    v_lshrrev_b32 v34, 1, v2
    v_cndmask_b32 v8, 0, v32, s[96:97]
    v_cndmask_b32 v9, 0, v32, s[98:99]
    v_cmp_eq_u32 s[96:97], 2, v33
    v_cmp_eq_u32 s[98:99], 3, v33
    v_and_b32 v35, 1, v2
    v_cndmask_b32 v10, 0, v32, s[96:97]
    v_cndmask_b32 v11, 0, v32, s[98:99]
    v_lshl_add_u32 v12, v35, 1, v34
    v_lshlrev_b32 v32, 4, v35
    v_lshl_add_u32 v13, v34, 9, v32
    v_lshl_add_u32 v13, v3, 5, v13
    v_mul_u32_u24 v34, 2304, v34
    v_add_u32 v32, v32, v34
    v_lshl_add_u32 v15, v4, 5, v32
    v_lshl_add_u32 v15, v5, 30, v15
    v_lshl_add_u32 v64, v3, 5, v32
    v_add_u32 v20, 77824, v7
    v_add_u32 v21, 126976, v7
    s_lshl_b32 s60, s44, 10
    v_add_u32 v67, s60, v20
    v_add_u32 v68, s60, v21
    v_mov_b32 v32, 0
    v_mov_b32 v33, 0
    s_waitcnt vmcnt(0)
    ds_write_b128 v36, v[44:47] offset:1024
    ds_write_b128 v36, v[48:51] offset:1536
    ds_write_b32 v37, v52 offset:2048
    ds_read_u16 v54, v38 offset:1024
    ds_read_u16 v55, v38 offset:1056
    ds_read_u16 v56, v38 offset:1088
    ds_read_u16 v57, v38 offset:1120
    ds_read_u16 v53, v39 offset:1152
    v_dot2c_f32_bf16 v32, s68, v44
    v_dot2c_f32_bf16 v32, s68, v45
    v_dot2c_f32_bf16 v32, s68, v46
    v_dot2c_f32_bf16 v32, s68, v47
    v_dot2c_f32_bf16 v32, s68, v48
    v_dot2c_f32_bf16 v32, s68, v49
    v_dot2c_f32_bf16 v32, s68, v50
    v_dot2c_f32_bf16 v32, s68, v51
    v_dot2c_f32_bf16 v32, s68, v52
    v_lshlrev_b32 v104, 16, v44
    v_and_b32 v105, s69, v44
    v_lshlrev_b32 v106, 16, v45
    v_add_f32_dpp v32, v32, v32 quad_perm:[1,0,3,2] row_mask:0xf bank_mask:0xf
    v_and_b32 v107, s69, v45
    v_lshlrev_b32 v108, 16, v46
    v_and_b32 v109, s69, v46
    v_add_f32_dpp v32, v32, v32 quad_perm:[2,3,0,1] row_mask:0xf bank_mask:0xf
    v_lshlrev_b32 v110, 16, v47
    v_and_b32 v111, s69, v47
    v_lshlrev_b32 v112, 16, v48
    v_add_f32_dpp v32, v32, v32 row_half_mirror row_mask:0xf bank_mask:0xf
    v_and_b32 v113, s69, v48
    v_lshlrev_b32 v114, 16, v49
    v_and_b32 v115, s69, v49
    v_mov_b32 v34, v32
    v_lshlrev_b32 v116, 16, v50
    v_and_b32 v117, s69, v50
    v_lshlrev_b32 v118, 16, v51
    v_permlane16_swap_b32 v32, v34
    v_add_f32 v32, v32, v34
    v_mov_b32 v34, v32
    v_and_b32 v119, s69, v51
    v_lshlrev_b32 v120, 16, v52
    v_and_b32 v121, s69, v52
    v_permlane32_swap_b32 v32, v34
    v_add_f32 v32, v32, v34
    v_mul_f32 v32, 0x3ae38e39, v32
    v_mov_b32 v33, v32
    v_pk_add_f32 v[104:105], v[104:105], v[32:33] neg_lo:[0,1] neg_hi:[0,1]
    v_pk_add_f32 v[106:107], v[106:107], v[32:33] neg_lo:[0,1] neg_hi:[0,1]
    v_pk_add_f32 v[108:109], v[108:109], v[32:33] neg_lo:[0,1] neg_hi:[0,1]
    v_pk_add_f32 v[110:111], v[110:111], v[32:33] neg_lo:[0,1] neg_hi:[0,1]
    v_pk_add_f32 v[112:113], v[112:113], v[32:33] neg_lo:[0,1] neg_hi:[0,1]
    v_pk_add_f32 v[114:115], v[114:115], v[32:33] neg_lo:[0,1] neg_hi:[0,1]
    v_pk_add_f32 v[116:117], v[116:117], v[32:33] neg_lo:[0,1] neg_hi:[0,1]
    v_pk_add_f32 v[118:119], v[118:119], v[32:33] neg_lo:[0,1] neg_hi:[0,1]
    v_pk_add_f32 v[120:121], v[120:121], v[32:33] neg_lo:[0,1] neg_hi:[0,1]
    v_pk_mul_f32 v[34:35], v[104:105], v[104:105]
    v_pk_mul_f32 v[122:123], v[106:107], v[106:107]
    v_pk_fma_f32 v[34:35], v[108:109], v[108:109], v[34:35]
    v_pk_fma_f32 v[122:123], v[110:111], v[110:111], v[122:123]
    v_pk_fma_f32 v[34:35], v[112:113], v[112:113], v[34:35]
    v_pk_fma_f32 v[122:123], v[114:115], v[114:115], v[122:123]
    v_pk_fma_f32 v[34:35], v[116:117], v[116:117], v[34:35]
    v_pk_fma_f32 v[122:123], v[118:119], v[118:119], v[122:123]
    v_pk_fma_f32 v[34:35], v[120:121], v[120:121], v[34:35]
    v_pk_add_f32 v[34:35], v[34:35], v[122:123]
    v_add_f32 v33, v34, v35
    s_nop 1
    v_add_f32_dpp v33, v33, v33 quad_perm:[1,0,3,2] row_mask:0xf bank_mask:0xf
    s_nop 1
    v_add_f32_dpp v33, v33, v33 quad_perm:[2,3,0,1] row_mask:0xf bank_mask:0xf
    s_nop 1
    v_add_f32_dpp v33, v33, v33 row_half_mirror row_mask:0xf bank_mask:0xf
    v_mov_b32 v34, v33
    s_nop 1
    v_permlane16_swap_b32 v33, v34
    v_add_f32 v33, v33, v34
    v_mov_b32 v34, v33
    s_nop 1
    v_permlane32_swap_b32 v33, v34
    v_add_f32 v33, v33, v34
    v_mul_f32 v33, 0x3ae38e39, v33
    v_cvt_pk_bf16_f32 v65, 0, v32
    v_cvt_pk_bf16_f32 v33, 0, v33
    v_add_f32 v33, 0x3727c5ac, v33
    v_cvt_pk_bf16_f32 v33, 0, v33
    v_sqrt_f32 v33, v33
    s_nop 0
    v_cvt_pk_bf16_f32 v33, 0, v33
    v_rcp_f32 v66, v33
    s_waitcnt lgkmcnt(0)
    s_lshr_b32 s50, s49, 0
    s_add_u32 s50, s50, 1
    s_and_b32 s50, s50, 0xff
    s_lshr_b32 s51, s49, 8
    s_add_u32 s51, s51, 1
    s_and_b32 s51, s51, 0xff
    s_lshr_b32 s52, s49, 16
    s_add_u32 s52, s52, 1
    s_and_b32 s52, s52, 0xff
    s_lshr_b32 s53, s49, 24
    s_add_u32 s53, s53, 1
    s_and_b32 s53, s53, 0xff
    s_lshl_b32 s60, s51, 8
    s_or_b32 s49, s50, s60
    s_lshl_b32 s60, s52, 16
    s_or_b32 s49, s49, s60
    s_lshl_b32 s60, s53, 24
    s_or_b32 s49, s49, s60
    s_lshl_b32 s54, s42, 3
    s_add_u32 s54, s54, s41
    s_lshl_b32 s54, s54, 10
    s_add_u32 s54, s54, 4096
    s_cmp_lt_u32 s44, 2
    s_cselect_b32 s60, -1, 0
    s_and_b32 s61, s44, 1
    s_lshl_b32 s61, s61, 10
    v_add_u32 v40, s61, v21
    v_lshlrev_b32 v34, 16, v54
    v_lshlrev_b32 v35, 16, v55
    v_lshlrev_b32 v36, 16, v56
    v_lshlrev_b32 v37, 16, v57
    v_lshlrev_b32 v38, 16, v53
    v_sub_f32 v34, v34, v65
    v_sub_f32 v35, v35, v65
    v_sub_f32 v36, v36, v65
    v_sub_f32 v37, v37, v65
    v_sub_f32 v38, v38, v65
    v_cvt_pk_bf16_f32 v34, 0, v34
    v_cvt_pk_bf16_f32 v35, 0, v35
    v_cvt_pk_bf16_f32 v36, 0, v36
    v_cvt_pk_bf16_f32 v37, 0, v37
    v_cvt_pk_bf16_f32 v38, 0, v38
    v_mul_f32 v34, v34, v66
    v_mul_f32 v35, v35, v66
    v_mul_f32 v36, v36, v66
    v_mul_f32 v37, v37, v66
    v_mul_f32 v38, v38, v66
    v_cvt_pk_bf16_f32 v69, v34, v34
    v_cvt_pk_bf16_f32 v70, v35, v35
    v_cvt_pk_bf16_f32 v71, v36, v36
    v_cvt_pk_bf16_f32 v72, v37, v37
    v_cvt_pk_bf16_f32 v73, v38, v38
    v_and_b32 v73, s60, v73
    s_nop 1
L_lw_5:
    ds_read_b32 v18, v17 offset:0
    s_sub_u32 s63, s63, 1
    s_cbranch_scc1 L_end
    s_waitcnt lgkmcnt(0)
    v_readfirstlane_b32 s62, v18
    s_cmp_lt_u32 s62, 1
    s_cbranch_scc1 L_lw_5
    ds_read_b128 v[104:107], v68 offset:0
    ds_read_b128 v[108:111], v68 offset:4096
    ds_read_b128 v[112:115], v68 offset:8192
    ds_read_b128 v[116:119], v68 offset:12288
    ds_read_b128 v[120:123], v40 offset:16384
    v_and_b32 v24, v69, v8
    v_and_b32 v25, v69, v9
    v_and_b32 v26, v69, v10
    v_and_b32 v27, v69, v11
    v_and_b32 v28, v70, v8
    v_and_b32 v29, v70, v9
    v_and_b32 v30, v70, v10
    v_and_b32 v31, v70, v11
    s_waitcnt lgkmcnt(4)
    v_mfma_f32_16x16x32_bf16 v[100:103], v[24:27], v[104:107], 0
    v_and_b32 v24, v71, v8
    v_and_b32 v25, v71, v9
    v_and_b32 v26, v71, v10
    v_and_b32 v27, v71, v11
    s_waitcnt lgkmcnt(3)
    v_mfma_f32_16x16x32_bf16 v[100:103], v[28:31], v[108:111], v[100:103]
    v_and_b32 v28, v72, v8
    v_and_b32 v29, v72, v9
    v_and_b32 v30, v72, v10
    v_and_b32 v31, v72, v11
    s_waitcnt lgkmcnt(2)
    v_mfma_f32_16x16x32_bf16 v[100:103], v[24:27], v[112:115], v[100:103]
    v_and_b32 v24, v73, v8
    v_and_b32 v25, v73, v9
    v_and_b32 v26, v73, v10
    v_and_b32 v27, v73, v11
    s_waitcnt lgkmcnt(1)
    v_mfma_f32_16x16x32_bf16 v[100:103], v[28:31], v[116:119], v[100:103]
    s_waitcnt lgkmcnt(0)
    v_mfma_f32_16x16x32_bf16 v[100:103], v[24:27], v[120:123], v[100:103]
    s_nop 7
    ds_write_b128 v68, v[100:103]
    s_mov_b64 exec, 1
    ds_add_rtn_u32 v32, v17, v16 offset:4
    s_mov_b64 exec, -1
    s_waitcnt lgkmcnt(0)
    v_readfirstlane_b32 s62, v32
    s_cmp_lg_u32 s62, 3
    s_cbranch_scc1 L_qpub_6
    ds_read_b128 v[32:35], v21 offset:0
    ds_read_b128 v[36:39], v21 offset:1024
    ds_read_b128 v[40:43], v21 offset:2048
    ds_read_b128 v[44:47], v21 offset:3072
    s_mov_b64 exec, 1
    ds_add_u32 v17, v16 offset:24
    s_mov_b64 exec, -1
    s_waitcnt lgkmcnt(3)
    v_pk_add_f32 v[32:33], v[32:33], v[36:37]
    v_pk_add_f32 v[34:35], v[34:35], v[38:39]
    s_waitcnt lgkmcnt(1)
    v_pk_add_f32 v[40:41], v[40:41], v[44:45]
    v_pk_add_f32 v[42:43], v[42:43], v[46:47]
    v_pk_add_f32 v[32:33], v[32:33], v[40:41]
    v_pk_add_f32 v[34:35], v[34:35], v[42:43]
    v_bfi_b32 v32, v6, s50, v32
    v_bfi_b32 v33, v6, s51, v33
    v_bfi_b32 v34, v6, s52, v34
    v_bfi_b32 v35, v6, s53, v35
    buffer_store_dwordx4 v[32:35], v13, s[32:35], s54 offen offset:0 sc1
    s_nop 1
L_qpub_6:
    s_cmp_ge_u32 s45, 27
    s_cbranch_scc1 L_X_light
    s_and_b32 s6, s101, 127
    s_bfe_u32 s58, s101, 0x20007
    v_lshrrev_b32 v32, 1, v4
    v_lshlrev_b32 v22, 8, v32
    v_lshrrev_b32 v32, 1, v2
    v_lshl_add_u32 v22, v32, 6, v22
    v_lshl_add_u32 v22, v5, 7, v22
    v_and_b32 v32, 1, v1
    v_lshl_add_u32 v22, v32, 5, v22
    v_and_b32 v32, 1, v2
    v_lshl_add_u32 v22, v32, 4, v22
    v_bfe_i32 v32, v1, 2, 1
    v_xor_b32 v32, v32, v1
    v_and_b32 v32, 3, v32
    v_lshlrev_b32 v23, 4, v32
    v_lshl_add_u32 v23, v5, 6, v23
    v_bfe_u32 v32, v1, 2, 1
    v_lshl_add_u32 v23, v32, 7, v23
    v_lshl_add_u32 v23, v2, 10, v23
    s_and_b32 s60, s6, 1
    v_xor_b32 v32, s60, v32
    v_mul_u32_u24 v32, 3072, v32
    v_add_u32 v23, v23, v32
    v_and_b32 v75, 4294967167, v68
    s_and_b32 s3, s6, 0xfe
    s_mul_i32 s3, s3, 3072
    s_lshl_b32 s60, s44, 8
    s_add_u32 s3, s3, s60
    s_add_u32 s3, s3, 528384
    s_mul_i32 s66, s6, 4736
    s_mul_i32 s60, s58, 768
    s_add_u32 s66, s66, s60
    s_add_u32 s66, s66, 1052672
    v_and_b32 v32, 4, v1
    v_cmp_eq_u32 s[96:97], 4, v32
    v_mov_b32 v46, 0xc0135761
    s_cmp_eq_u32 s44, 3
    s_cbranch_scc1 L_nog_7
    s_cmp_lt_u32 s44, 2
    s_cbranch_scc1 L_xprep_8
    ds_read_u16 v104, v74 offset:1096
    ds_read_u16 v105, v74 offset:1098
    ds_read_u16 v106, v74 offset:1100
    ds_read_u16 v107, v74 offset:1102
    ds_read_u16 v108, v74 offset:1104
    ds_read_u16 v109, v74 offset:1106
    ds_read_u16 v110, v74 offset:1108
    ds_read_u16 v111, v74 offset:1110
    ds_read_u16 v112, v74 offset:1112
    ds_read_u16 v113, v74 offset:1114
    ds_read_u16 v114, v74 offset:1116
    ds_read_u16 v115, v74 offset:1118
    v_add_u32 v48, 69632, v7
    s_waitcnt lgkmcnt(0)
    v_lshlrev_b32 v120, 16, v104
    v_lshlrev_b32 v121, 16, v105
    v_lshlrev_b32 v122, 16, v106
    v_lshlrev_b32 v123, 16, v107
    v_lshlrev_b32 v124, 16, v108
    v_lshlrev_b32 v125, 16, v109
    v_lshlrev_b32 v126, 16, v110
    v_lshlrev_b32 v127, 16, v111
    v_lshlrev_b32 v128, 16, v112
    v_lshlrev_b32 v129, 16, v113
    v_lshlrev_b32 v130, 16, v114
    v_lshlrev_b32 v131, 16, v115
    v_sub_f32 v120, v120, v65
    v_sub_f32 v121, v121, v65
    v_sub_f32 v122, v122, v65
    v_sub_f32 v123, v123, v65
    v_sub_f32 v124, v124, v65
    v_sub_f32 v125, v125, v65
    v_sub_f32 v126, v126, v65
    v_sub_f32 v127, v127, v65
    v_sub_f32 v128, v128, v65
    v_sub_f32 v129, v129, v65
    v_sub_f32 v130, v130, v65
    v_sub_f32 v131, v131, v65
    v_cvt_pk_bf16_f32 v120, 0, v120
    v_cvt_pk_bf16_f32 v121, 0, v121
    v_cvt_pk_bf16_f32 v122, 0, v122
    v_cvt_pk_bf16_f32 v123, 0, v123
    v_cvt_pk_bf16_f32 v124, 0, v124
    v_cvt_pk_bf16_f32 v125, 0, v125
    v_cvt_pk_bf16_f32 v126, 0, v126
    v_cvt_pk_bf16_f32 v127, 0, v127
    v_cvt_pk_bf16_f32 v128, 0, v128
    v_cvt_pk_bf16_f32 v129, 0, v129
    v_cvt_pk_bf16_f32 v130, 0, v130
    v_cvt_pk_bf16_f32 v131, 0, v131
    v_mul_f32 v120, v120, v66
    v_mul_f32 v121, v121, v66
    v_mul_f32 v122, v122, v66
    v_mul_f32 v123, v123, v66
    v_mul_f32 v124, v124, v66
    v_mul_f32 v125, v125, v66
    v_mul_f32 v126, v126, v66
    v_mul_f32 v127, v127, v66
    v_mul_f32 v128, v128, v66
    v_mul_f32 v129, v129, v66
    v_mul_f32 v130, v130, v66
    v_mul_f32 v131, v131, v66
    v_cvt_pk_bf16_f32 v76, v120, v120
    v_cvt_pk_bf16_f32 v77, v121, v121
    v_cvt_pk_bf16_f32 v78, v122, v122
    v_cvt_pk_bf16_f32 v79, v123, v123
    v_cvt_pk_bf16_f32 v80, v124, v124
    v_cvt_pk_bf16_f32 v81, v125, v125
    v_cvt_pk_bf16_f32 v82, v126, v126
    v_cvt_pk_bf16_f32 v83, v127, v127
    v_cvt_pk_bf16_f32 v84, v128, v128
    v_cvt_pk_bf16_f32 v85, v129, v129
    v_cvt_pk_bf16_f32 v86, v130, v130
    v_cvt_pk_bf16_f32 v87, v131, v131
    v_and_b32 v120, v76, v8
    v_and_b32 v121, v76, v9
    v_and_b32 v122, v76, v10
    v_and_b32 v123, v76, v11
    ds_write_b128 v48, v[120:123] offset:45056
    v_and_b32 v124, v77, v8
    v_and_b32 v125, v77, v9
    v_and_b32 v126, v77, v10
    v_and_b32 v127, v77, v11
    ds_write_b128 v48, v[124:127] offset:46080
    v_and_b32 v128, v78, v8
    v_and_b32 v129, v78, v9
    v_and_b32 v130, v78, v10
    v_and_b32 v131, v78, v11
    ds_write_b128 v48, v[128:131] offset:47104
    v_and_b32 v132, v79, v8
    v_and_b32 v133, v79, v9
    v_and_b32 v134, v79, v10
    v_and_b32 v135, v79, v11
    ds_write_b128 v48, v[132:135] offset:48128
    v_and_b32 v136, v80, v8
    v_and_b32 v137, v80, v9
    v_and_b32 v138, v80, v10
    v_and_b32 v139, v80, v11
    ds_write_b128 v48, v[136:139] offset:49152
    v_and_b32 v140, v81, v8
    v_and_b32 v141, v81, v9
    v_and_b32 v142, v81, v10
    v_and_b32 v143, v81, v11
    ds_write_b128 v48, v[140:143] offset:50176
    v_and_b32 v144, v82, v8
    v_and_b32 v145, v82, v9
    v_and_b32 v146, v82, v10
    v_and_b32 v147, v82, v11
    ds_write_b128 v48, v[144:147] offset:51200
    v_and_b32 v148, v83, v8
    v_and_b32 v149, v83, v9
    v_and_b32 v150, v83, v10
    v_and_b32 v151, v83, v11
    ds_write_b128 v48, v[148:151] offset:52224
    v_and_b32 v152, v84, v8
    v_and_b32 v153, v84, v9
    v_and_b32 v154, v84, v10
    v_and_b32 v155, v84, v11
    ds_write_b128 v48, v[152:155] offset:53248
    v_and_b32 v156, v85, v8
    v_and_b32 v157, v85, v9
    v_and_b32 v158, v85, v10
    v_and_b32 v159, v85, v11
    ds_write_b128 v48, v[156:159] offset:54272
    v_and_b32 v160, v86, v8
    v_and_b32 v161, v86, v9
    v_and_b32 v162, v86, v10
    v_and_b32 v163, v86, v11
    ds_write_b128 v48, v[160:163] offset:55296
    v_and_b32 v164, v87, v8
    v_and_b32 v165, v87, v9
    v_and_b32 v166, v87, v10
    v_and_b32 v167, v87, v11
    ds_write_b128 v48, v[164:167] offset:56320
    ds_write_b32 v48, v22 offset:2048
    s_mov_b64 exec, 1
    ds_add_u32 v17, v16 offset:32
    s_mov_b64 exec, -1
    s_branch L_nog_7
L_xprep_8:
    s_lshl_b32 s60, s44, 1
    v_add_u32 v74, s60, v74
    ds_read_u16 v104, v74 offset:1024
    ds_read_u16 v105, v74 offset:1028
    ds_read_u16 v106, v74 offset:1032
    ds_read_u16 v107, v74 offset:1036
    ds_read_u16 v108, v74 offset:1040
    ds_read_u16 v109, v74 offset:1044
    ds_read_u16 v110, v74 offset:1048
    ds_read_u16 v111, v74 offset:1052
    ds_read_u16 v112, v74 offset:1056
    ds_read_u16 v113, v74 offset:1060
    ds_read_u16 v114, v74 offset:1064
    ds_read_u16 v115, v74 offset:1068
    s_waitcnt lgkmcnt(4)
    ds_read_u16 v116, v74 offset:1072
    ds_read_u16 v117, v74 offset:1076
    ds_read_u16 v118, v74 offset:1080
    ds_read_u16 v119, v74 offset:1084
    ds_read_u16 v120, v74 offset:1088
    ds_read_u16 v121, v74 offset:1092
    s_waitcnt lgkmcnt(0)
    v_lshlrev_b32 v128, 16, v104
    v_lshlrev_b32 v129, 16, v105
    v_lshlrev_b32 v130, 16, v106
    v_lshlrev_b32 v131, 16, v107
    v_lshlrev_b32 v132, 16, v108
    v_lshlrev_b32 v133, 16, v109
    v_lshlrev_b32 v134, 16, v110
    v_lshlrev_b32 v135, 16, v111
    v_lshlrev_b32 v136, 16, v112
    v_lshlrev_b32 v137, 16, v113
    v_lshlrev_b32 v138, 16, v114
    v_lshlrev_b32 v139, 16, v115
    v_lshlrev_b32 v140, 16, v116
    v_lshlrev_b32 v141, 16, v117
    v_lshlrev_b32 v142, 16, v118
    v_lshlrev_b32 v143, 16, v119
    v_lshlrev_b32 v144, 16, v120
    v_lshlrev_b32 v145, 16, v121
    v_sub_f32 v128, v128, v65
    v_sub_f32 v129, v129, v65
    v_sub_f32 v130, v130, v65
    v_sub_f32 v131, v131, v65
    v_sub_f32 v132, v132, v65
    v_sub_f32 v133, v133, v65
    v_sub_f32 v134, v134, v65
    v_sub_f32 v135, v135, v65
    v_sub_f32 v136, v136, v65
    v_sub_f32 v137, v137, v65
    v_sub_f32 v138, v138, v65
    v_sub_f32 v139, v139, v65
    v_sub_f32 v140, v140, v65
    v_sub_f32 v141, v141, v65
    v_sub_f32 v142, v142, v65
    v_sub_f32 v143, v143, v65
    v_sub_f32 v144, v144, v65
    v_sub_f32 v145, v145, v65
    v_cvt_pk_bf16_f32 v128, 0, v128
    v_cvt_pk_bf16_f32 v129, 0, v129
    v_cvt_pk_bf16_f32 v130, 0, v130
    v_cvt_pk_bf16_f32 v131, 0, v131
    v_cvt_pk_bf16_f32 v132, 0, v132
    v_cvt_pk_bf16_f32 v133, 0, v133
    v_cvt_pk_bf16_f32 v134, 0, v134
    v_cvt_pk_bf16_f32 v135, 0, v135
    v_cvt_pk_bf16_f32 v136, 0, v136
    v_cvt_pk_bf16_f32 v137, 0, v137
    v_cvt_pk_bf16_f32 v138, 0, v138
    v_cvt_pk_bf16_f32 v139, 0, v139
    v_cvt_pk_bf16_f32 v140, 0, v140
    v_cvt_pk_bf16_f32 v141, 0, v141
    v_cvt_pk_bf16_f32 v142, 0, v142
    v_cvt_pk_bf16_f32 v143, 0, v143
    v_cvt_pk_bf16_f32 v144, 0, v144
    v_cvt_pk_bf16_f32 v145, 0, v145
    v_mul_f32 v128, v128, v66
    v_mul_f32 v129, v129, v66
    v_mul_f32 v130, v130, v66
    v_mul_f32 v131, v131, v66
    v_mul_f32 v132, v132, v66
    v_mul_f32 v133, v133, v66
    v_mul_f32 v134, v134, v66
    v_mul_f32 v135, v135, v66
    v_mul_f32 v136, v136, v66
    v_mul_f32 v137, v137, v66
    v_mul_f32 v138, v138, v66
    v_mul_f32 v139, v139, v66
    v_mul_f32 v140, v140, v66
    v_mul_f32 v141, v141, v66
    v_mul_f32 v142, v142, v66
    v_mul_f32 v143, v143, v66
    v_mul_f32 v144, v144, v66
    v_mul_f32 v145, v145, v66
    v_cvt_pk_bf16_f32 v76, v128, v128
    v_cvt_pk_bf16_f32 v77, v129, v129
    v_cvt_pk_bf16_f32 v78, v130, v130
    v_cvt_pk_bf16_f32 v79, v131, v131
    v_cvt_pk_bf16_f32 v80, v132, v132
    v_cvt_pk_bf16_f32 v81, v133, v133
    v_cvt_pk_bf16_f32 v82, v134, v134
    v_cvt_pk_bf16_f32 v83, v135, v135
    v_cvt_pk_bf16_f32 v84, v136, v136
    v_cvt_pk_bf16_f32 v85, v137, v137
    v_cvt_pk_bf16_f32 v86, v138, v138
    v_cvt_pk_bf16_f32 v87, v139, v139
    v_cvt_pk_bf16_f32 v88, v140, v140
    v_cvt_pk_bf16_f32 v89, v141, v141
    v_cvt_pk_bf16_f32 v90, v142, v142
    v_cvt_pk_bf16_f32 v91, v143, v143
    v_cvt_pk_bf16_f32 v92, v144, v144
    v_cvt_pk_bf16_f32 v93, v145, v145
    v_and_b32 v144, v90, v8
    v_and_b32 v145, v90, v9
    v_and_b32 v146, v90, v10
    v_and_b32 v147, v90, v11
    v_and_b32 v148, v91, v8
    v_and_b32 v149, v91, v9
    v_and_b32 v150, v91, v10
    v_and_b32 v151, v91, v11
    v_and_b32 v152, v92, v8
    v_and_b32 v153, v92, v9
    v_and_b32 v154, v92, v10
    v_and_b32 v155, v92, v11
    v_and_b32 v156, v93, v8
    v_and_b32 v157, v93, v9
    v_and_b32 v158, v93, v10
    v_and_b32 v159, v93, v11
    s_nop 1
L_lw_9:
    ds_read_b32 v18, v17 offset:0
    s_sub_u32 s63, s63, 1
    s_cbranch_scc1 L_end
    s_sleep 2
    s_waitcnt lgkmcnt(0)
    v_readfirstlane_b32 s62, v18
    s_cmp_lt_u32 s62, 9
    s_cbranch_scc1 L_lw_9
    ds_read_b128 v[104:107], v67 offset:0
    ds_read_b128 v[108:111], v67 offset:2048
    ds_read_b128 v[112:115], v67 offset:4096
    ds_read_b128 v[116:119], v67 offset:6144
    ds_read_b128 v[120:123], v67 offset:8192
    ds_read_b128 v[124:127], v67 offset:10240
    ds_read_b128 v[128:131], v67 offset:12288
    ds_read_b128 v[132:135], v67 offset:14336
    v_and_b32 v28, v76, v8
    v_and_b32 v29, v76, v9
    v_and_b32 v30, v76, v10
    v_and_b32 v31, v76, v11
    v_and_b32 v24, v77, v8
    v_and_b32 v25, v77, v9
    v_and_b32 v26, v77, v10
    v_and_b32 v27, v77, v11
    s_waitcnt lgkmcnt(7)
    v_mfma_f32_16x16x32_bf16 v[100:103], v[28:31], v[104:107], 0
    v_and_b32 v28, v78, v8
    v_and_b32 v29, v78, v9
    v_and_b32 v30, v78, v10
    v_and_b32 v31, v78, v11
    s_waitcnt lgkmcnt(6)
    v_mfma_f32_16x16x32_bf16 v[100:103], v[24:27], v[108:111], v[100:103]
    v_and_b32 v24, v79, v8
    v_and_b32 v25, v79, v9
    v_and_b32 v26, v79, v10
    v_and_b32 v27, v79, v11
    s_waitcnt lgkmcnt(5)
    v_mfma_f32_16x16x32_bf16 v[100:103], v[28:31], v[112:115], v[100:103]
    v_and_b32 v28, v80, v8
    v_and_b32 v29, v80, v9
    v_and_b32 v30, v80, v10
    v_and_b32 v31, v80, v11
    s_waitcnt lgkmcnt(4)
    v_mfma_f32_16x16x32_bf16 v[100:103], v[24:27], v[116:119], v[100:103]
    v_and_b32 v24, v81, v8
    v_and_b32 v25, v81, v9
    v_and_b32 v26, v81, v10
    v_and_b32 v27, v81, v11
    s_waitcnt lgkmcnt(3)
    v_mfma_f32_16x16x32_bf16 v[100:103], v[28:31], v[120:123], v[100:103]
    v_and_b32 v28, v82, v8
    v_and_b32 v29, v82, v9
    v_and_b32 v30, v82, v10
    v_and_b32 v31, v82, v11
    s_waitcnt lgkmcnt(2)
    v_mfma_f32_16x16x32_bf16 v[100:103], v[24:27], v[124:127], v[100:103]
    v_and_b32 v24, v83, v8
    v_and_b32 v25, v83, v9
    v_and_b32 v26, v83, v10
    v_and_b32 v27, v83, v11
    s_waitcnt lgkmcnt(1)
    v_mfma_f32_16x16x32_bf16 v[100:103], v[28:31], v[128:131], v[100:103]
    s_waitcnt lgkmcnt(0)
    v_mfma_f32_16x16x32_bf16 v[100:103], v[24:27], v[132:135], v[100:103]
    s_nop 7
L_lw_10:
    ds_read_b32 v18, v17 offset:0
    s_sub_u32 s63, s63, 1
    s_cbranch_scc1 L_end
    s_sleep 1
    s_waitcnt lgkmcnt(0)
    v_readfirstlane_b32 s62, v18
    s_cmp_lt_u32 s62, 12
    s_cbranch_scc1 L_lw_10
    ds_read_b128 v[104:107], v67 offset:16384
    ds_read_b128 v[108:111], v67 offset:18432
    ds_read_b128 v[112:115], v67 offset:20480
    ds_read_b128 v[116:119], v67 offset:22528
    ds_read_b128 v[120:123], v67 offset:24576
    ds_read_b128 v[124:127], v67 offset:26624
    v_and_b32 v28, v84, v8
    v_and_b32 v29, v84, v9
    v_and_b32 v30, v84, v10
    v_and_b32 v31, v84, v11
    v_and_b32 v24, v85, v8
    v_and_b32 v25, v85, v9
    v_and_b32 v26, v85, v10
    v_and_b32 v27, v85, v11
    s_waitcnt lgkmcnt(5)
    v_mfma_f32_16x16x32_bf16 v[100:103], v[28:31], v[104:107], v[100:103]
    v_and_b32 v28, v86, v8
    v_and_b32 v29, v86, v9
    v_and_b32 v30, v86, v10
    v_and_b32 v31, v86, v11
    s_waitcnt lgkmcnt(4)
    v_mfma_f32_16x16x32_bf16 v[100:103], v[24:27], v[108:111], v[100:103]
    v_and_b32 v24, v87, v8
    v_and_b32 v25, v87, v9
    v_and_b32 v26, v87, v10
    v_and_b32 v27, v87, v11
    s_waitcnt lgkmcnt(3)
    v_mfma_f32_16x16x32_bf16 v[100:103], v[28:31], v[112:115], v[100:103]
    v_and_b32 v28, v88, v8
    v_and_b32 v29, v88, v9
    v_and_b32 v30, v88, v10
    v_and_b32 v31, v88, v11
    s_waitcnt lgkmcnt(2)
    v_mfma_f32_16x16x32_bf16 v[100:103], v[24:27], v[116:119], v[100:103]
    v_and_b32 v24, v89, v8
    v_and_b32 v25, v89, v9
    v_and_b32 v26, v89, v10
    v_and_b32 v27, v89, v11
    s_waitcnt lgkmcnt(1)
    v_mfma_f32_16x16x32_bf16 v[100:103], v[28:31], v[120:123], v[100:103]
    s_waitcnt lgkmcnt(0)
    v_mfma_f32_16x16x32_bf16 v[100:103], v[24:27], v[124:127], v[100:103]
L_lw_11:
    ds_read_b32 v18, v17 offset:0
    ds_read_b128 v[48:51], v67 offset:28672
    ds_read_b128 v[52:55], v67 offset:30720
    ds_read_b128 v[56:59], v67 offset:32768
    ds_read_b128 v[60:63], v67 offset:34816
    s_sub_u32 s63, s63, 1
    s_cbranch_scc1 L_end
    s_waitcnt lgkmcnt(0)
    v_readfirstlane_b32 s62, v18
    s_cmp_lt_u32 s62, 14
    s_cbranch_scc1 L_lw_11
    v_mfma_f32_16x16x32_bf16 v[100:103], v[144:147], v[48:51], v[100:103]
    v_mfma_f32_16x16x32_bf16 v[100:103], v[148:151], v[52:55], v[100:103]
    v_mfma_f32_16x16x32_bf16 v[100:103], v[152:155], v[56:59], v[100:103]
    v_mfma_f32_16x16x32_bf16 v[100:103], v[156:159], v[60:63], v[100:103]
    v_add_u32 v32, 4294959104, v67
    s_nop 6
    ds_write_b128 v32, v[100:103]
    s_mov_b64 exec, 1
    ds_add_u32 v17, v16 offset:36
    s_mov_b64 exec, -1
L_nog_7:
    v_mov_b32 v32, 0
    v_mov_b32 v33, 0
    v_mov_b32 v34, 0
    v_mov_b32 v35, 0
    s_mov_b32 s84, 0xffffffff
    s_mov_b32 s85, 0xffff
L_lw_14:
    ds_read_b32 v18, v17 offset:0
    s_sub_u32 s63, s63, 1
    s_cbranch_scc1 L_end
    s_sleep 1
    s_waitcnt lgkmcnt(0)
    v_readfirstlane_b32 s62, v18
    s_cmp_lt_u32 s62, 22
    s_cbranch_scc1 L_lw_14
    s_mov_b64 exec, s[84:85]
    buffer_load_dwordx4 v[32:35], v23, s[32:35], s3 offen sc1
    s_mov_b64 exec, -1
    s_mov_b64 exec, s[84:85]
    s_waitcnt vmcnt(0)
    v_xor_b32 v32, s50, v32
    v_xor_b32 v33, s51, v33
    v_xor_b32 v34, s52, v34
    v_xor_b32 v35, s53, v35
    v_or3_b32 v44, v32, v33, v34
    v_bitop3_b32 v44, v44, v35, v6 bitop3:0xa8
    v_cmp_ne_u32 s[84:85], 0, v44
    s_mov_b64 exec, -1
    s_or_b64 vcc, s[84:85], s[84:85]
    s_cbranch_scc1 L_h_again_13
L_h_chk_12:
    ds_read_b32 v18, v17 offset:0
    ds_read_b128 v[104:107], v68 offset:0
    ds_read_b128 v[108:111], v75 offset:16384
    ds_read_b128 v[112:115], v68 offset:4096
    ds_read_b128 v[116:119], v75 offset:16512
    ds_read_b128 v[120:123], v68 offset:8192
    ds_read_b128 v[124:127], v75 offset:20480
    ds_read_b128 v[128:131], v68 offset:12288
    ds_read_b128 v[132:135], v75 offset:20608
    v_permlane32_swap_b32 v32, v33
    v_permlane32_swap_b32 v34, v35
    v_add_f32 v32, v32, v33
    v_add_f32 v34, v34, v35
    s_nop 1
    v_permlane16_swap_b32 v32, v34
    v_add_f32 v32, v32, v34
    v_cvt_pk_bf16_f32 v32, 0, v32
    v_mul_f32 v33, v32, v32
    v_fmac_f32 v46, 0xbdd2d3e8, v33
    v_mul_f32 v33, v46, v32
    v_exp_f32 v33, v33
    s_nop 0
    v_add_f32 v33, 1.0, v33
    v_rcp_f32 v33, v33
    s_nop 0
    v_mul_f32 v33, v33, v32
    v_cvt_pk_bf16_f32 v33, 0, v33
    v_cndmask_b32 v33, v33, v32, s[96:97]
    s_waitcnt lgkmcnt(0)
    v_readfirstlane_b32 s62, v18
    v_mul_f32_dpp v46, v33, v33 row_half_mirror row_mask:0xf bank_mask:0xf
    v_cvt_pk_bf16_f32 v46, v46, v46
    s_cmp_lt_u32 s62, 23
    s_cbranch_scc1 L_dlate_15
L_dhave_16:
    v_and_b32_dpp v28, v46, v8 quad_perm:[0,0,0,0] row_mask:0xf bank_mask:0xf
    v_and_b32_dpp v29, v46, v9 quad_perm:[0,0,0,0] row_mask:0xf bank_mask:0xf
    v_and_b32_dpp v30, v46, v10 quad_perm:[3,3,3,3] row_mask:0xf bank_mask:0xf
    v_and_b32_dpp v31, v46, v11 quad_perm:[3,3,3,3] row_mask:0xf bank_mask:0xf
    v_and_b32_dpp v24, v46, v8 quad_perm:[1,1,1,1] row_mask:0xf bank_mask:0xf
    v_and_b32_dpp v25, v46, v9 quad_perm:[1,1,1,1] row_mask:0xf bank_mask:0xf
    v_and_b32_dpp v26, v46, v10 quad_perm:[2,2,2,2] row_mask:0xf bank_mask:0xf
    v_and_b32_dpp v27, v46, v11 quad_perm:[2,2,2,2] row_mask:0xf bank_mask:0xf
    v_mfma_f32_16x16x32_bf16 v[136:139], v[28:31], v[104:107], 0
    v_mfma_f32_16x16x32_bf16 v[140:143], v[28:31], v[108:111], 0
    v_and_b32_dpp v28, v46, v8 quad_perm:[2,2,2,2] row_mask:0xf bank_mask:0xf
    v_and_b32_dpp v29, v46, v9 quad_perm:[2,2,2,2] row_mask:0xf bank_mask:0xf
    v_and_b32_dpp v30, v46, v10 quad_perm:[1,1,1,1] row_mask:0xf bank_mask:0xf
    v_and_b32_dpp v31, v46, v11 quad_perm:[1,1,1,1] row_mask:0xf bank_mask:0xf
    v_mfma_f32_16x16x32_bf16 v[136:139], v[24:27], v[112:115], v[136:139]
    v_mfma_f32_16x16x32_bf16 v[140:143], v[24:27], v[116:119], v[140:143]
    v_and_b32_dpp v24, v46, v8 quad_perm:[3,3,3,3] row_mask:0xf bank_mask:0xf
    v_and_b32_dpp v25, v46, v9 quad_perm:[3,3,3,3] row_mask:0xf bank_mask:0xf
    v_and_b32_dpp v26, v46, v10 quad_perm:[0,0,0,0] row_mask:0xf bank_mask:0xf
    v_and_b32_dpp v27, v46, v11 quad_perm:[0,0,0,0] row_mask:0xf bank_mask:0xf
    v_mfma_f32_16x16x32_bf16 v[136:139], v[28:31], v[120:123], v[136:139]
    v_mfma_f32_16x16x32_bf16 v[140:143], v[28:31], v[124:127], v[140:143]
    v_mfma_f32_16x16x32_bf16 v[136:139], v[24:27], v[128:131], v[136:139]
    v_mfma_f32_16x16x32_bf16 v[140:143], v[24:27], v[132:135], v[140:143]
    s_nop 6
    ds_write_b128 v68, v[136:139]
    ds_write_b128 v68, v[140:143] offset:4096
    s_mov_b64 exec, 1
    ds_add_rtn_u32 v18, v17, v16 offset:20
    s_mov_b64 exec, -1
    ds_read_b128 v[32:35], v21 offset:0
    ds_read_b128 v[36:39], v21 offset:1024
    ds_read_b128 v[40:43], v21 offset:2048
    ds_read_b128 v[44:47], v21 offset:3072
    ds_read_b128 v[48:51], v21 offset:4096
    ds_read_b128 v[52:55], v21 offset:5120
    ds_read_b128 v[56:59], v21 offset:6144
    ds_read_b128 v[60:63], v21 offset:7168
    s_waitcnt lgkmcnt(8)
    v_readfirstlane_b32 s62, v18
    s_cmp_lg_u32 s62, 3
    s_cbranch_scc1 L_xdone_17
    s_waitcnt lgkmcnt(6)
    v_pk_add_f32 v[32:33], v[32:33], v[36:37]
    v_pk_add_f32 v[34:35], v[34:35], v[38:39]
    s_waitcnt lgkmcnt(4)
    v_pk_add_f32 v[40:41], v[40:41], v[44:45]
    v_pk_add_f32 v[42:43], v[42:43], v[46:47]
    v_pk_add_f32 v[32:33], v[32:33], v[40:41]
    v_pk_add_f32 v[34:35], v[34:35], v[42:43]
    v_bfi_b32 v32, v6, s50, v32
    v_bfi_b32 v33, v6, s51, v33
    v_bfi_b32 v34, v6, s52, v34
    v_bfi_b32 v35, v6, s53, v35
    buffer_store_dwordx4 v[32:35], v64, s[32:35], s66 offen offset:0 sc1
    s_waitcnt lgkmcnt(2)
    v_pk_add_f32 v[48:49], v[48:49], v[52:53]
    v_pk_add_f32 v[50:51], v[50:51], v[54:55]
    s_waitcnt lgkmcnt(0)
    v_pk_add_f32 v[56:57], v[56:57], v[60:61]
    v_pk_add_f32 v[58:59], v[58:59], v[62:63]
    v_pk_add_f32 v[48:49], v[48:49], v[56:57]
    v_pk_add_f32 v[50:51], v[50:51], v[58:59]
    v_bfi_b32 v48, v6, s50, v48
    v_bfi_b32 v49, v6, s51, v49
    v_bfi_b32 v50, v6, s52, v50
    v_bfi_b32 v51, v6, s53, v51
    buffer_store_dwordx4 v[48:51], v15, s[32:35], s66 offen offset:512 sc1
    s_waitcnt vmcnt(0)
    s_mov_b64 exec, 1
    ds_add_u32 v17, v16 offset:20
    s_mov_b64 exec, -1
L_xdone_17:
    s_endpgm
L_h_again_13:
    s_mov_b64 exec, s[84:85]
    s_cbranch_execz L_ms_18
    buffer_load_dwordx4 v[32:35], v23, s[32:35], s3 offen sc1
L_ms_18:
    s_mov_b64 exec, -1
    s_sub_u32 s63, s63, 1
    s_cbranch_scc1 L_end
    s_waitcnt vmcnt(0)
    s_mov_b64 exec, s[84:85]
    s_cbranch_execz L_mz_19
    v_xor_b32 v32, s50, v32
    v_xor_b32 v33, s51, v33
    v_xor_b32 v34, s52, v34
    v_xor_b32 v35, s53, v35
    v_or3_b32 v44, v32, v33, v34
    v_bitop3_b32 v44, v44, v35, v6 bitop3:0xa8
    v_cmp_ne_u32 s[84:85], 0, v44
L_mz_19:
    s_mov_b64 exec, -1
    s_or_b64 vcc, s[84:85], s[84:85]
    s_cbranch_scc1 L_h_again_13
    s_branch L_h_chk_12
L_dlate_15:
L_lw_20:
    ds_read_b32 v18, v17 offset:0
    s_sub_u32 s63, s63, 1
    s_cbranch_scc1 L_end
    s_waitcnt lgkmcnt(0)
    v_readfirstlane_b32 s62, v18
    s_cmp_lt_u32 s62, 23
    s_cbranch_scc1 L_lw_20
    ds_read_b128 v[104:107], v68 offset:0
    ds_read_b128 v[108:111], v75 offset:16384
    ds_read_b128 v[112:115], v68 offset:4096
    ds_read_b128 v[116:119], v75 offset:16512
    ds_read_b128 v[120:123], v68 offset:8192
    ds_read_b128 v[124:127], v75 offset:20480
    ds_read_b128 v[128:131], v68 offset:12288
    ds_read_b128 v[132:135], v75 offset:20608
    s_waitcnt lgkmcnt(0)
    s_branch L_dhave_16
L_X_light:
    s_bfe_u32 s7, s101, 0x60009
    s_lshr_b32 s60, s7, 2
    s_lshl_b32 s54, s60, 14
    s_add_u32 s54, s54, 266240
    s_and_b32 s60, s7, 3
    s_lshl_b32 s60, s60, 8
    s_add_u32 s54, s54, s60
    s_lshl_b32 s60, s44, 6
    s_add_u32 s54, s54, s60
    v_bfe_u32 v54, v1, 2, 1
    v_lshl_add_u32 v54, v2, 1, v54
    v_lshl_add_u32 v54, v5, 3, v54
    v_lshlrev_b32 v54, 10, v54
    v_and_b32 v55, 3, v1
    v_lshl_add_u32 v54, v55, 4, v54
    s_mul_i32 s66, s7, 4736
    s_add_u32 s66, s66, 749568
    s_mul_i32 s60, s44, 18432
    s_add_u32 s61, s60, 77824
    v_mul_u32_u24 v32, 1152, v12
    v_add_u32 v32, s61, v32
    v_lshl_add_u32 v22, v3, 4, v32
    v_lshl_add_u32 v23, v4, 4, v32
    v_mov_b32 v68, v67
    v_add_u32 v67, s60, v20
    s_mul_i32 s67, s44, 18
    s_add_u32 s67, s67, 41
    s_lshr_b32 s67, s67, 2
    s_lshl_b32 s67, s44, 1
    s_add_u32 s67, s67, 17
    s_lshl_b32 s60, s44, 9
    s_add_u32 s55, s66, s60
L_lw_21:
    ds_read_b32 v18, v17 offset:0
    s_sub_u32 s63, s63, 1
    s_cbranch_scc1 L_end
    s_sleep 2
    s_waitcnt lgkmcnt(0)
    v_readfirstlane_b32 s62, v18
    s_cmp_lt_u32 s62, 14
    s_cbranch_scc1 L_lw_21
    buffer_load_dwordx4 v[60:63], v54, s[32:35], s54 offen sc1
    ds_read_b128 v[88:91], v22 offset:0
    ds_read_b128 v[92:95], v22 offset:256
    ds_read_b128 v[96:99], v22 offset:512
    ds_read_b128 v[100:103], v22 offset:768
    ds_read_b128 v[104:107], v23 offset:1024
    ds_read_b128 v[108:111], v22 offset:4608
    ds_read_b128 v[112:115], v22 offset:4864
    ds_read_b128 v[116:119], v22 offset:5120
    ds_read_b128 v[120:123], v22 offset:5376
    ds_read_b128 v[124:127], v23 offset:5632
L_o_chk_22:
    s_waitcnt vmcnt(0)
    v_cmp_ne_u32 vcc, s49, v63
    s_cmp_lg_u64 vcc, 0
    s_cbranch_scc1 L_o_again_23
    v_lshlrev_b32 v63, 16, v62
    v_and_b32 v62, s69, v62
    v_lshlrev_b32 v56, 16, v60
    v_max_f32_dpp v32, v63, v63 row_shl:4 row_mask:0xf bank_mask:0x5
    s_nop 1
    v_max_f32_dpp v32, v63, v63 row_shr:4 row_mask:0xf bank_mask:0xa
    v_and_b32 v57, s69, v60
    v_lshlrev_b32 v58, 16, v61
    v_and_b32 v59, s69, v61
    v_mov_b32 v33, v32
    s_nop 1
    v_permlane16_swap_b32 v32, v33
    v_max_f32 v32, v32, v33
    v_mov_b32 v33, v32
    s_nop 1
    v_permlane32_swap_b32 v32, v33
    v_max_f32 v32, v32, v33
    v_sub_f32 v63, v63, v32
    v_mul_f32 v63, 0x3fb8aa3b, v63
    v_exp_f32 v63, v63
    s_nop 0
    v_mul_f32 v62, v62, v63
    v_mul_f32 v56, v56, v62
    v_mul_f32 v57, v57, v62
    v_mul_f32 v58, v58, v62
    v_mul_f32 v59, v59, v62
    v_mov_b32 v33, v62
    s_nop 1
    v_permlane16_swap_b32 v62, v33
    v_add_f32 v62, v62, v33
    v_mov_b32 v33, v62
    s_nop 1
    v_permlane32_swap_b32 v62, v33
    v_add_f32 v62, v62, v33
    v_permlane32_swap_b32 v56, v57
    v_permlane32_swap_b32 v58, v59
    v_add_f32 v56, v56, v57
    v_add_f32 v58, v58, v59
    s_nop 1
    v_permlane16_swap_b32 v56, v58
    v_add_f32 v56, v56, v58
    v_add_f32_dpp v32, v62, v62 row_shl:4 row_mask:0xf bank_mask:0x5
    s_nop 1
    v_add_f32_dpp v32, v62, v62 row_shr:4 row_mask:0xf bank_mask:0xa
    v_add_f32_dpp v63, v56, v56 row_shl:4 row_mask:0xf bank_mask:0x5
    s_nop 1
    v_add_f32_dpp v63, v56, v56 row_shr:4 row_mask:0xf bank_mask:0xa
    v_rcp_f32 v32, v32
    s_nop 0
    v_mul_f32 v63, v63, v32
    v_cvt_pk_bf16_f32 v56, v63, v63
    s_nop 1
    v_and_b32_dpp v72, v56, v8 quad_perm:[0,0,0,0] row_mask:0xf bank_mask:0xf
    v_and_b32_dpp v73, v56, v9 quad_perm:[0,0,0,0] row_mask:0xf bank_mask:0xf
    v_and_b32_dpp v74, v56, v10 quad_perm:[0,0,0,0] row_mask:0xf bank_mask:0xf
    v_and_b32_dpp v75, v56, v11 quad_perm:[0,0,0,0] row_mask:0xf bank_mask:0xf
    v_and_b32_dpp v76, v56, v8 quad_perm:[1,1,1,1] row_mask:0xf bank_mask:0xf
    v_and_b32_dpp v77, v56, v9 quad_perm:[1,1,1,1] row_mask:0xf bank_mask:0xf
    v_and_b32_dpp v78, v56, v10 quad_perm:[1,1,1,1] row_mask:0xf bank_mask:0xf
    v_and_b32_dpp v79, v56, v11 quad_perm:[1,1,1,1] row_mask:0xf bank_mask:0xf
    v_and_b32_dpp v80, v56, v8 quad_perm:[2,2,2,2] row_mask:0xf bank_mask:0xf
    v_and_b32_dpp v81, v56, v9 quad_perm:[2,2,2,2] row_mask:0xf bank_mask:0xf
    v_and_b32_dpp v82, v56, v10 quad_perm:[2,2,2,2] row_mask:0xf bank_mask:0xf
    v_and_b32_dpp v83, v56, v11 quad_perm:[2,2,2,2] row_mask:0xf bank_mask:0xf
    v_and_b32_dpp v84, v56, v8 quad_perm:[3,3,3,3] row_mask:0xf bank_mask:0xf
    v_and_b32_dpp v85, v56, v9 quad_perm:[3,3,3,3] row_mask:0xf bank_mask:0xf
    v_and_b32_dpp v86, v56, v10 quad_perm:[3,3,3,3] row_mask:0xf bank_mask:0xf
    v_and_b32_dpp v87, v56, v11 quad_perm:[3,3,3,3] row_mask:0xf bank_mask:0xf
    s_waitcnt lgkmcnt(0)
    v_mfma_f32_16x16x32_bf16 v[32:35], v[72:75], v[88:91], 0
    v_mfma_f32_16x16x32_bf16 v[36:39], v[72:75], v[92:95], 0
    v_mfma_f32_16x16x32_bf16 v[40:43], v[72:75], v[96:99], 0
    v_mfma_f32_16x16x32_bf16 v[44:47], v[72:75], v[100:103], 0
    v_mfma_f32_16x16x32_bf16 v[48:51], v[72:75], v[104:107], 0
    s_waitcnt lgkmcnt(0)
    v_mfma_f32_16x16x32_bf16 v[32:35], v[76:79], v[108:111], v[32:35]
    v_mfma_f32_16x16x32_bf16 v[36:39], v[76:79], v[112:115], v[36:39]
    v_mfma_f32_16x16x32_bf16 v[40:43], v[76:79], v[116:119], v[40:43]
    v_mfma_f32_16x16x32_bf16 v[44:47], v[76:79], v[120:123], v[44:47]
    v_mfma_f32_16x16x32_bf16 v[48:51], v[76:79], v[124:127], v[48:51]
L_lw_24:
    ds_read_b32 v18, v17 offset:0
    s_sub_u32 s63, s63, 1
    s_cbranch_scc1 L_end
    s_waitcnt lgkmcnt(0)
    v_readfirstlane_b32 s62, v18
    s_cmp_lt_u32 s62, s67
    s_cbranch_scc1 L_lw_24
    ds_read_b128 v[128:131], v22 offset:9216
    ds_read_b128 v[132:135], v22 offset:9472
    ds_read_b128 v[136:139], v22 offset:9728
    ds_read_b128 v[140:143], v22 offset:9984
    ds_read_b128 v[144:147], v23 offset:10240
    ds_read_b128 v[148:151], v22 offset:13824
    ds_read_b128 v[152:155], v22 offset:14080
    ds_read_b128 v[156:159], v22 offset:14336
    ds_read_b128 v[160:163], v22 offset:14592
    ds_read_b128 v[164:167], v23 offset:14848
    s_waitcnt lgkmcnt(5)
    v_mfma_f32_16x16x32_bf16 v[32:35], v[80:83], v[128:131], v[32:35]
    v_mfma_f32_16x16x32_bf16 v[36:39], v[80:83], v[132:135], v[36:39]
    v_mfma_f32_16x16x32_bf16 v[40:43], v[80:83], v[136:139], v[40:43]
    v_mfma_f32_16x16x32_bf16 v[44:47], v[80:83], v[140:143], v[44:47]
    v_mfma_f32_16x16x32_bf16 v[48:51], v[80:83], v[144:147], v[48:51]
    s_waitcnt lgkmcnt(0)
    v_mfma_f32_16x16x32_bf16 v[32:35], v[84:87], v[148:151], v[32:35]
    v_mfma_f32_16x16x32_bf16 v[36:39], v[84:87], v[152:155], v[36:39]
    v_mfma_f32_16x16x32_bf16 v[40:43], v[84:87], v[156:159], v[40:43]
    v_mfma_f32_16x16x32_bf16 v[44:47], v[84:87], v[160:163], v[44:47]
    v_mfma_f32_16x16x32_bf16 v[48:51], v[84:87], v[164:167], v[48:51]
    s_nop 3
    ds_write_b128 v67, v[32:35] offset:0
    ds_write_b128 v67, v[36:39] offset:1024
    ds_write_b128 v67, v[40:43] offset:2048
    ds_write_b128 v67, v[44:47] offset:3072
    ds_write_b128 v67, v[48:51] offset:4096
    s_mov_b64 exec, 1
    ds_add_u32 v17, v16 offset:20
    s_mov_b64 exec, -1
L_lw_25:
    ds_read_b32 v18, v17 offset:20
    ds_read_b128 v[32:35], v68 offset:0
    ds_read_b128 v[36:39], v68 offset:18432
    ds_read_b128 v[40:43], v68 offset:36864
    ds_read_b128 v[44:47], v68 offset:55296
    ds_read_b128 v[48:51], v20 offset:4096
    ds_read_b128 v[52:55], v20 offset:22528
    ds_read_b128 v[56:59], v20 offset:40960
    ds_read_b128 v[60:63], v20 offset:59392
    s_sub_u32 s63, s63, 1
    s_cbranch_scc1 L_end
    s_waitcnt lgkmcnt(0)
    v_readfirstlane_b32 s62, v18
    s_cmp_lt_u32 s62, 4
    s_cbranch_scc1 L_lw_25
    s_waitcnt lgkmcnt(6)
    v_pk_add_f32 v[32:33], v[32:33], v[36:37]
    v_pk_add_f32 v[34:35], v[34:35], v[38:39]
    s_waitcnt lgkmcnt(4)
    v_pk_add_f32 v[40:41], v[40:41], v[44:45]
    v_pk_add_f32 v[42:43], v[42:43], v[46:47]
    v_pk_add_f32 v[32:33], v[32:33], v[40:41]
    v_pk_add_f32 v[34:35], v[34:35], v[42:43]
    v_bfi_b32 v32, v6, s50, v32
    v_bfi_b32 v33, v6, s51, v33
    v_bfi_b32 v34, v6, s52, v34
    v_bfi_b32 v35, v6, s53, v35
    buffer_store_dwordx4 v[32:35], v64, s[32:35], s55 offen offset:0 sc1
    s_cmp_lg_u32 s44, 0
    s_cbranch_scc1 L_ldone_26
    s_waitcnt lgkmcnt(0)
    v_pk_add_f32 v[48:49], v[48:49], v[52:53]
    v_pk_add_f32 v[50:51], v[50:51], v[54:55]
    v_pk_add_f32 v[56:57], v[56:57], v[60:61]
    v_pk_add_f32 v[58:59], v[58:59], v[62:63]
    v_pk_add_f32 v[48:49], v[48:49], v[56:57]
    v_pk_add_f32 v[50:51], v[50:51], v[58:59]
    v_bfi_b32 v48, v6, s50, v48
    v_bfi_b32 v49, v6, s51, v49
    v_bfi_b32 v50, v6, s52, v50
    v_bfi_b32 v51, v6, s53, v51
    buffer_store_dwordx4 v[48:51], v15, s[32:35], s66 offen offset:2048 sc1
    s_nop 1
L_ldone_26:
    s_endpgm
L_o_again_23:
    buffer_load_dwordx4 v[60:63], v54, s[32:35], s54 offen sc1
    s_sub_u32 s63, s63, 1
    s_cbranch_scc0 L_o_chk_22
    s_endpgm
L_role_A:
    s_sub_u32 s44, s43, 5
    s_mov_b32 s32, s30
    s_mov_b32 s33, s31
    s_mov_b32 s34, 1393664
    s_mov_b32 s35, 0x20000
    s_load_dword s49, s[32:33], 0
    s_lshl_b32 s60, s2, 2
    s_add_u32 s60, s60, L_roles-L_pc
    s_load_dword s101, s[4:5], s60
    s_mov_b32 s69, 0xffff0000
    s_mov_b32 s63, 1048576
    s_lshr_b32 s45, s2, 3
    v_and_b32 v1, 63, v0
    v_mov_b32 v6, 0xff
    v_mov_b32 v16, 1
    v_lshlrev_b32 v7, 4, v1
    v_and_b32 v32, 1, v0
    v_lshlrev_b32 v32, 4, v32
    v_mov_b32 v33, 0xffff
    v_lshlrev_b32 v32, v32, v33
    v_lshrrev_b32 v33, 1, v4
    v_cmp_eq_u32 s[96:97], 0, v33
    v_cmp_eq_u32 s[98:99], 1, v33
    v_lshrrev_b32 v34, 1, v2
    v_cndmask_b32 v8, 0, v32, s[96:97]
    v_cndmask_b32 v9, 0, v32, s[98:99]
    v_cmp_eq_u32 s[96:97], 2, v33
    v_cmp_eq_u32 s[98:99], 3, v33
    v_and_b32 v35, 1, v2
    v_cndmask_b32 v10, 0, v32, s[96:97]
    v_cndmask_b32 v11, 0, v32, s[98:99]
    v_lshl_add_u32 v12, v35, 1, v34
    v_lshlrev_b32 v32, 4, v35
    v_lshl_add_u32 v13, v34, 9, v32
    v_lshl_add_u32 v13, v3, 5, v13
    v_mul_u32_u24 v34, 2304, v34
    v_add_u32 v32, v32, v34
    v_lshl_add_u32 v15, v4, 5, v32
    v_lshl_add_u32 v15, v5, 30, v15
    v_add_u32 v22, 4096, v7
    s_lshl_b32 s60, s44, 13
    v_add_u32 v21, s60, v22
    s_and_b32 s66, s40, 0xfe
    s_lshr_b32 s60, s44, 1
    s_add_u32 s66, s66, s60
    s_lshl_b32 s66, s66, 13
    s_and_b32 s60, s40, 1
    s_lshl_b32 s60, s60, 9
    s_add_u32 s66, s66, s60
    s_and_b32 s60, s44, 1
    s_lshl_b32 s60, s60, 8
    s_add_u32 s66, s66, s60
    s_add_u32 s66, s66, 4096
    s_add_u32 s67, s66, 4096
    v_lshlrev_b32 v32, 4, v3
    v_lshl_add_u32 v20, v2, 10, v32
    s_waitcnt lgkmcnt(0)
    s_lshr_b32 s50, s49, 0
    s_add_u32 s50, s50, 1
    s_and_b32 s50, s50, 0xff
    s_lshr_b32 s51, s49, 8
    s_add_u32 s51, s51, 1
    s_and_b32 s51, s51, 0xff
    s_lshr_b32 s52, s49, 16
    s_add_u32 s52, s52, 1
    s_and_b32 s52, s52, 0xff
    s_lshr_b32 s53, s49, 24
    s_add_u32 s53, s53, 1
    s_and_b32 s53, s53, 0xff
    s_lshl_b32 s60, s51, 8
    s_or_b32 s49, s50, s60
    s_lshl_b32 s60, s52, 16
    s_or_b32 s49, s49, s60
    s_lshl_b32 s60, s53, 24
    s_or_b32 s49, s49, s60
    s_bfe_u32 s7, s101, 0x60009
    s_bfe_u32 s57, s101, 0x4000f
    s_mul_i32 s58, s7, 4736
    s_lshl_b32 s61, s57, 8
    s_add_u32 s58, s58, s61
    s_add_u32 s58, s58, 749568
    s_lshl_b32 s59, s40, 3
    s_add_u32 s59, s59, s41
    s_mul_i32 s59, s59, 1024
    s_add_u32 s59, s59, 266240
    s_lshl_b32 s60, s44, 7
    v_lshl_add_u32 v148, v3, 2, v12
    v_lshl_add_u32 v148, v148, 1, s60
    v_and_b32 v149, 1, v1
    v_lshl_add_u32 v149, v149, 2, v2
    v_lshlrev_b32 v149, 4, v149
    v_lshl_add_u32 v149, v5, 8, v149
    s_lshl_b32 s60, s44, 3
    v_lshl_add_u32 v150, v5, 5, s60
    s_lshl_b32 s60, s44, 10
    s_add_u32 s60, s60, 69632
    v_add_u32 v155, s60, v7
    v_and_b32 v155, 4294967167, v155
    s_lshl_b32 s60, s7, 2
    s_add_u32 s60, s60, s44
    s_mul_i32 s60, s60, 18432
    s_lshl_b32 s61, s57, 7
    s_add_u32 s60, s60, s61
    v_lshl_add_u32 v32, v5, 2, v12
    v_mul_u32_u24 v32, 1152, v32
    v_lshl_add_u32 v32, v4, 4, v32
    v_add_u32 v155, s60, v32
    s_lshr_b32 s42, s101, 19
    s_min_u32 s56, s42, 143
    v_lshrrev_b32 v32, 1, v1
    v_mul_u32_u24 v151, 4736, v32
    v_and_b32 v32, 7, v32
    v_mul_u32_u24 v152, 4736, v32
    v_and_b32 v32, 1, v1
    v_lshl_add_u32 v151, v32, 4, v151
    v_lshl_add_u32 v152, v32, 4, v152
    v_lshl_add_u32 v153, v32, 2, v12
    s_lshl_b32 s60, s56, 4
    v_lshl_add_u32 v153, v153, 1, s60
    global_load_ushort v154, v153, s[8:9]
    v_cmp_lt_u32 vcc, 1, v3
    v_mov_b32 v32, 1073741824
    s_mov_b32 s36, s26
    s_mov_b32 s37, s27
    v_cndmask_b32 v153, v153, v32, vcc
    s_mov_b32 s38, 2304
    s_mov_b32 s39, 0x20000
    s_lshl_b32 s60, s56, 5
    s_add_u32 s3, s60, 749568
    s_add_u32 s4, s60, 901120
    s_add_u32 s5, s60, 1052672
    s_add_u32 s18, s60, 1204224
    s_add_u32 s19, s60, 1355776
    s_waitcnt vmcnt(0)
L_lw_27:
    ds_read_b32 v18, v17 offset:0
    s_sub_u32 s63, s63, 1
    s_cbranch_scc1 L_end
    s_sleep 1
    s_waitcnt lgkmcnt(0)
    v_readfirstlane_b32 s62, v18
    s_cmp_lt_u32 s62, 3
    s_cbranch_scc1 L_lw_27
    buffer_load_dwordx4 v[56:59], v20, s[32:35], s66 offen sc1
    buffer_load_dwordx4 v[60:63], v20, s[32:35], s67 offen sc1
    ds_read_b128 v[64:67], v21 offset:0
    ds_read_b128 v[68:71], v21 offset:1024
    ds_read_b128 v[72:75], v21 offset:2048
    ds_read_b128 v[76:79], v21 offset:3072
    ds_read_b128 v[80:83], v21 offset:4096
    ds_read_b128 v[84:87], v21 offset:5120
    ds_read_b128 v[88:91], v21 offset:6144
    ds_read_b128 v[92:95], v21 offset:7168
L_q_chk_28:
    s_waitcnt vmcnt(0)
    v_xor_b32 v56, s50, v56
    v_xor_b32 v57, s51, v57
    v_xor_b32 v58, s52, v58
    v_xor_b32 v59, s53, v59
    v_xor_b32 v60, s50, v60
    v_xor_b32 v61, s51, v61
    v_xor_b32 v62, s52, v62
    v_xor_b32 v63, s53, v63
    v_or3_b32 v32, v56, v57, v58
    v_or3_b32 v32, v32, v59, v60
    v_or3_b32 v32, v32, v61, v62
    v_or_b32 v32, v32, v63
    v_and_b32 v32, v6, v32
    v_cmp_ne_u32 vcc, 0, v32
    s_cmp_lg_u64 vcc, 0
    s_cbranch_scc1 L_q_again_29
    v_pk_add_f32 v[56:57], v[56:57], v[60:61]
    v_pk_add_f32 v[58:59], v[58:59], v[62:63]
    s_nop 0
    v_permlane32_swap_b32 v56, v57
    v_permlane32_swap_b32 v58, v59
    v_add_f32 v56, v56, v57
    v_add_f32 v58, v58, v59
    s_nop 1
    v_permlane16_swap_b32 v56, v58
    v_add_f32 v56, v56, v58
    v_cvt_pk_bf16_f32 v56, v56, v56
    ds_write_b16 v148, v56 offset:128
    s_mov_b64 exec, 1
    ds_add_u32 v17, v16 offset:8
    s_mov_b64 exec, -1
L_lw_30:
    ds_read_b32 v32, v17 offset:8
    ds_read_b128 v[56:59], v149 offset:128
    ds_read_b128 v[60:63], v149 offset:256
    s_sub_u32 s63, s63, 1
    s_cbranch_scc1 L_end
    s_waitcnt lgkmcnt(0)
    v_readfirstlane_b32 s62, v32
    s_cmp_lt_u32 s62, 4
    s_cbranch_scc1 L_lw_30
    v_mfma_f32_16x16x32_bf16 v[128:131], v[64:67], v[56:59], 0
    v_mfma_f32_16x16x32_bf16 v[132:135], v[72:75], v[56:59], 0
    v_mfma_f32_16x16x32_bf16 v[136:139], v[80:83], v[56:59], 0
    v_mfma_f32_16x16x32_bf16 v[140:143], v[88:91], v[56:59], 0
    s_waitcnt lgkmcnt(0)
    v_mfma_f32_16x16x32_bf16 v[128:131], v[68:71], v[60:63], v[128:131]
    v_mfma_f32_16x16x32_bf16 v[132:135], v[76:79], v[60:63], v[132:135]
    v_mfma_f32_16x16x32_bf16 v[136:139], v[84:87], v[60:63], v[136:139]
    v_mfma_f32_16x16x32_bf16 v[140:143], v[92:95], v[60:63], v[140:143]
    s_nop 4
    v_mov_b32_dpp v32, v128 quad_perm:[0,0,2,2] row_mask:0xf bank_mask:0xf
    v_mov_b32_dpp v33, v129 quad_perm:[0,0,2,2] row_mask:0xf bank_mask:0xf
    v_mov_b32_dpp v34, v132 quad_perm:[0,0,2,2] row_mask:0xf bank_mask:0xf
    v_mov_b32_dpp v35, v133 quad_perm:[0,0,2,2] row_mask:0xf bank_mask:0xf
    v_mov_b32_dpp v36, v136 quad_perm:[0,0,2,2] row_mask:0xf bank_mask:0xf
    v_mov_b32_dpp v37, v137 quad_perm:[0,0,2,2] row_mask:0xf bank_mask:0xf
    v_mov_b32_dpp v38, v140 quad_perm:[0,0,2,2] row_mask:0xf bank_mask:0xf
    v_mov_b32_dpp v39, v141 quad_perm:[0,0,2,2] row_mask:0xf bank_mask:0xf
    v_add_f32_dpp v32, v130, v32 quad_perm:[1,1,3,3] row_mask:0xf bank_mask:0xf
    v_add_f32_dpp v33, v131, v33 quad_perm:[1,1,3,3] row_mask:0xf bank_mask:0xf
    v_add_f32_dpp v34, v134, v34 quad_perm:[1,1,3,3] row_mask:0xf bank_mask:0xf
    v_add_f32_dpp v35, v135, v35 quad_perm:[1,1,3,3] row_mask:0xf bank_mask:0xf
    v_add_f32_dpp v36, v138, v36 quad_perm:[1,1,3,3] row_mask:0xf bank_mask:0xf
    v_add_f32_dpp v37, v139, v37 quad_perm:[1,1,3,3] row_mask:0xf bank_mask:0xf
    v_add_f32_dpp v38, v142, v38 quad_perm:[1,1,3,3] row_mask:0xf bank_mask:0xf
    v_add_f32_dpp v39, v143, v39 quad_perm:[1,1,3,3] row_mask:0xf bank_mask:0xf
    v_cvt_pk_bf16_f32 v32, 0, v32
    v_cvt_pk_bf16_f32 v33, 0, v33
    v_cvt_pk_bf16_f32 v34, 0, v34
    v_cvt_pk_bf16_f32 v35, 0, v35
    v_cvt_pk_bf16_f32 v36, 0, v36
    v_cvt_pk_bf16_f32 v37, 0, v37
    v_cvt_pk_bf16_f32 v38, 0, v38
    v_cvt_pk_bf16_f32 v39, 0, v39
    s_mov_b32 s60, 0x3db504f3
    v_mul_f32 v32, s60, v32
    v_mul_f32 v33, s60, v33
    v_mul_f32 v34, s60, v34
    v_mul_f32 v35, s60, v35
    v_mul_f32 v36, s60, v36
    v_mul_f32 v37, s60, v37
    v_mul_f32 v38, s60, v38
    v_mul_f32 v39, s60, v39
    v_cvt_pk_bf16_f32 v32, 0, v32
    v_cvt_pk_bf16_f32 v33, 0, v33
    v_cvt_pk_bf16_f32 v34, 0, v34
    v_cvt_pk_bf16_f32 v35, 0, v35
    v_cvt_pk_bf16_f32 v36, 0, v36
    v_cvt_pk_bf16_f32 v37, 0, v37
    v_cvt_pk_bf16_f32 v38, 0, v38
    v_cvt_pk_bf16_f32 v39, 0, v39
    v_max3_f32 v44, v32, v33, v34
    v_max3_f32 v45, v35, v36, v37
    v_max3_f32 v44, v44, v38, v39
    v_max_f32 v44, v44, v45
    v_mov_b32 v46, v44
    s_nop 1
    v_permlane16_swap_b32 v44, v46
    v_max_f32 v44, v44, v46
    v_mov_b32 v46, v44
    s_nop 1
    v_permlane32_swap_b32 v44, v46
    v_max_f32 v44, v44, v46
    s_mov_b32 s60, 0x3fb8aa3b
    v_sub_f32 v32, v32, v44
    v_sub_f32 v33, v33, v44
    v_sub_f32 v34, v34, v44
    v_sub_f32 v35, v35, v44
    v_sub_f32 v36, v36, v44
    v_sub_f32 v37, v37, v44
    v_sub_f32 v38, v38, v44
    v_sub_f32 v39, v39, v44
    v_mul_f32 v32, s60, v32
    v_mul_f32 v33, s60, v33
    v_mul_f32 v34, s60, v34
    v_mul_f32 v35, s60, v35
    v_mul_f32 v36, s60, v36
    v_mul_f32 v37, s60, v37
    v_mul_f32 v38, s60, v38
    v_mul_f32 v39, s60, v39
    v_exp_f32 v32, v32
    v_exp_f32 v33, v33
    v_exp_f32 v34, v34
    v_exp_f32 v35, v35
    v_exp_f32 v36, v36
    v_exp_f32 v37, v37
    v_exp_f32 v38, v38
    v_exp_f32 v39, v39
    v_add_f32 v45, v32, v33
    v_add_f32 v45, v45, v34
    v_add_f32 v45, v45, v35
    v_add_f32 v45, v45, v36
    v_add_f32 v45, v45, v37
    v_add_f32 v45, v45, v38
    v_add_f32 v45, v45, v39
    v_cvt_pk_bf16_f32 v32, v32, v32
    v_cvt_pk_bf16_f32 v33, v33, v33
    v_cvt_pk_bf16_f32 v34, v34, v34
    v_cvt_pk_bf16_f32 v35, v35, v35
    v_cvt_pk_bf16_f32 v36, v36, v36
    v_cvt_pk_bf16_f32 v37, v37, v37
    v_cvt_pk_bf16_f32 v38, v38, v38
    v_cvt_pk_bf16_f32 v39, v39, v39
    v_mov_b32 v46, v45
    s_nop 1
    v_permlane16_swap_b32 v45, v46
    v_add_f32 v45, v45, v46
    v_mov_b32 v46, v45
    s_nop 1
    v_permlane32_swap_b32 v45, v46
    v_add_f32 v45, v45, v46
    ds_write_b64 v150, v[44:45] offset:64
    s_nop 0
L_lw_31:
    ds_read_b32 v18, v17 offset:0
    s_sub_u32 s63, s63, 1
    s_cbranch_scc1 L_end
    s_waitcnt lgkmcnt(0)
    v_readfirstlane_b32 s62, v18
    s_cmp_lt_u32 s62, 5
    s_cbranch_scc1 L_lw_31
    ds_read_b128 v[96:99], v21 offset:32768
    ds_read_b128 v[100:103], v21 offset:33792
    ds_read_b128 v[104:107], v21 offset:34816
    ds_read_b128 v[108:111], v21 offset:35840
    ds_read_b128 v[112:115], v21 offset:36864
    ds_read_b128 v[116:119], v21 offset:37888
    ds_read_b128 v[120:123], v21 offset:38912
    ds_read_b128 v[124:127], v21 offset:39936
    v_and_b32 v28, v32, v8
    v_and_b32 v29, v32, v9
    v_and_b32 v30, v32, v10
    v_and_b32 v31, v32, v11
    v_and_b32 v24, v33, v8
    v_and_b32 v25, v33, v9
    v_and_b32 v26, v33, v10
    v_and_b32 v27, v33, v11
    s_waitcnt lgkmcnt(7)
    v_mfma_f32_16x16x32_bf16 v[144:147], v[28:31], v[96:99], 0
    v_and_b32 v28, v34, v8
    v_and_b32 v29, v34, v9
    v_and_b32 v30, v34, v10
    v_and_b32 v31, v34, v11
    s_waitcnt lgkmcnt(6)
    v_mfma_f32_16x16x32_bf16 v[144:147], v[24:27], v[100:103], v[144:147]
    v_and_b32 v24, v35, v8
    v_and_b32 v25, v35, v9
    v_and_b32 v26, v35, v10
    v_and_b32 v27, v35, v11
    s_waitcnt lgkmcnt(5)
    v_mfma_f32_16x16x32_bf16 v[144:147], v[28:31], v[104:107], v[144:147]
    v_and_b32 v28, v36, v8
    v_and_b32 v29, v36, v9
    v_and_b32 v30, v36, v10
    v_and_b32 v31, v36, v11
    s_waitcnt lgkmcnt(4)
    v_mfma_f32_16x16x32_bf16 v[144:147], v[24:27], v[108:111], v[144:147]
    v_and_b32 v24, v37, v8
    v_and_b32 v25, v37, v9
    v_and_b32 v26, v37, v10
    v_and_b32 v27, v37, v11
    s_waitcnt lgkmcnt(3)
    v_mfma_f32_16x16x32_bf16 v[144:147], v[28:31], v[112:115], v[144:147]
    v_and_b32 v28, v38, v8
    v_and_b32 v29, v38, v9
    v_and_b32 v30, v38, v10
    v_and_b32 v31, v38, v11
    s_waitcnt lgkmcnt(2)
    v_mfma_f32_16x16x32_bf16 v[144:147], v[24:27], v[116:119], v[144:147]
    v_and_b32 v24, v39, v8
    v_and_b32 v25, v39, v9
    v_and_b32 v26, v39, v10
    v_and_b32 v27, v39, v11
    s_waitcnt lgkmcnt(1)
    v_mfma_f32_16x16x32_bf16 v[144:147], v[28:31], v[120:123], v[144:147]
    s_waitcnt lgkmcnt(0)
    v_mfma_f32_16x16x32_bf16 v[144:147], v[24:27], v[124:127], v[144:147]
    v_lshrrev_b32 v56, 1, v2
    v_lshlrev_b32 v57, 5, v56
    s_nop 5
    ds_write_b128 v21, v[144:147]
    s_mov_b64 exec, 1
    ds_add_rtn_u32 v18, v17, v16 offset:12
    s_mov_b64 exec, -1
    ds_read_b128 v[48:51], v57 offset:64
    ds_read_b128 v[52:55], v57 offset:80
    ds_read_b128 v[32:35], v22 offset:0
    ds_read_b128 v[36:39], v22 offset:8192
    ds_read_b128 v[40:43], v22 offset:16384
    ds_read_b128 v[44:47], v22 offset:24576
    s_waitcnt lgkmcnt(6)
    v_readfirstlane_b32 s62, v18
    s_cmp_lg_u32 s62, 3
    s_cbranch_scc1 L_opub_32
    v_mov_b32 v63, s49
    s_waitcnt lgkmcnt(4)
    v_max3_f32 v60, v48, v50, v52
    v_max_f32 v60, v60, v54
    v_sub_f32 v48, v48, v60
    v_sub_f32 v50, v50, v60
    v_sub_f32 v52, v52, v60
    v_sub_f32 v54, v54, v60
    v_mul_f32 v48, s60, v48
    v_mul_f32 v50, s60, v50
    v_mul_f32 v52, s60, v52
    v_mul_f32 v54, s60, v54
    v_exp_f32 v48, v48
    v_exp_f32 v50, v50
    v_exp_f32 v52, v52
    v_exp_f32 v54, v54
    v_mul_f32 v61, v48, v49
    v_fmac_f32 v61, v50, v51
    v_fmac_f32 v61, v52, v53
    v_fmac_f32 v61, v54, v55
    v_cvt_pk_bf16_f32 v62, v60, v61
    v_rcp_f32 v49, v61
    s_waitcnt lgkmcnt(0)
    v_mul_f32 v32, v48, v32
    v_mul_f32 v33, v48, v33
    v_mul_f32 v34, v48, v34
    v_mul_f32 v35, v48, v35
    v_fmac_f32 v32, v50, v36
    v_fmac_f32 v33, v50, v37
    v_fmac_f32 v34, v50, v38
    v_fmac_f32 v35, v50, v39
    v_fmac_f32 v32, v52, v40
    v_fmac_f32 v33, v52, v41
    v_fmac_f32 v34, v52, v42
    v_fmac_f32 v35, v52, v43
    v_fmac_f32 v32, v54, v44
    v_fmac_f32 v33, v54, v45
    v_fmac_f32 v34, v54, v46
    v_fmac_f32 v35, v54, v47
    v_mul_f32 v32, v32, v49
    v_mul_f32 v33, v33, v49
    v_mul_f32 v34, v34, v49
    v_mul_f32 v35, v35, v49
    v_cvt_pk_bf16_f32 v60, v32, v33
    v_cvt_pk_bf16_f32 v61, v34, v35
    buffer_store_dwordx4 v[60:63], v13, s[32:35], s59 offen sc1
    s_nop 1
L_opub_32:
    s_cmp_ge_u32 s45, 27
    s_cbranch_scc1 L_adone_33
    s_waitcnt lgkmcnt(0)
    s_lshr_b32 s60, s7, 2
    s_lshl_b32 s54, s60, 14
    s_add_u32 s54, s54, 266240
    s_and_b32 s60, s7, 3
    s_lshl_b32 s60, s60, 8
    s_add_u32 s54, s54, s60
    s_lshl_b32 s60, s44, 6
    s_add_u32 s54, s54, s60
    v_bfe_u32 v54, v1, 2, 1
    v_lshl_add_u32 v54, v2, 1, v54
    v_lshl_add_u32 v54, v5, 3, v54
    v_lshlrev_b32 v54, 10, v54
    v_and_b32 v55, 3, v1
    v_lshl_add_u32 v54, v55, 4, v54
    s_nop 1
L_lw_34:
    ds_read_b32 v18, v17 offset:0
    s_sub_u32 s63, s63, 1
    s_cbranch_scc1 L_end
    s_sleep 2
    s_waitcnt lgkmcnt(0)
    v_readfirstlane_b32 s62, v18
    s_cmp_lt_u32 s62, 16
    s_cbranch_scc1 L_lw_34
    buffer_load_dwordx4 v[60:63], v54, s[32:35], s54 offen sc1
    s_nop 1
L_lw_35:
    ds_read_b32 v18, v17 offset:0
    s_sub_u32 s63, s63, 1
    s_cbranch_scc1 L_end
    s_sleep 1
    s_waitcnt lgkmcnt(0)
    v_readfirstlane_b32 s62, v18
    s_cmp_lt_u32 s62, 18
    s_cbranch_scc1 L_lw_35
    global_load_dwordx4 v[64:67], v155, s[16:17] sc1 nt
    v_add_u32 v155, 9216, v155
    global_load_dwordx4 v[68:71], v155, s[16:17] sc1 nt
    s_waitcnt vmcnt(2)
L_o_chk_36:
    v_cmp_ne_u32 vcc, s49, v63
    s_cmp_lg_u64 vcc, 0
    s_cbranch_scc1 L_o_again_37
    v_lshlrev_b32 v63, 16, v62
    v_and_b32 v62, s69, v62
    v_lshlrev_b32 v56, 16, v60
    v_max_f32_dpp v32, v63, v63 row_shl:4 row_mask:0xf bank_mask:0x5
    s_nop 1
    v_max_f32_dpp v32, v63, v63 row_shr:4 row_mask:0xf bank_mask:0xa
    v_and_b32 v57, s69, v60
    v_lshlrev_b32 v58, 16, v61
    v_and_b32 v59, s69, v61
    v_mov_b32 v33, v32
    s_nop 1
    v_permlane16_swap_b32 v32, v33
    v_max_f32 v32, v32, v33
    v_mov_b32 v33, v32
    s_nop 1
    v_permlane32_swap_b32 v32, v33
    v_max_f32 v32, v32, v33
    v_sub_f32 v63, v63, v32
    v_mul_f32 v63, 0x3fb8aa3b, v63
    v_exp_f32 v63, v63
    s_nop 0
    v_mul_f32 v62, v62, v63
    v_mul_f32 v56, v56, v62
    v_mul_f32 v57, v57, v62
    v_mul_f32 v58, v58, v62
    v_mul_f32 v59, v59, v62
    v_mov_b32 v33, v62
    s_nop 1
    v_permlane16_swap_b32 v62, v33
    v_add_f32 v62, v62, v33
    v_mov_b32 v33, v62
    s_nop 1
    v_permlane32_swap_b32 v62, v33
    v_add_f32 v62, v62, v33
    v_permlane32_swap_b32 v56, v57
    v_permlane32_swap_b32 v58, v59
    v_add_f32 v56, v56, v57
    v_add_f32 v58, v58, v59
    s_nop 1
    v_permlane16_swap_b32 v56, v58
    v_add_f32 v56, v56, v58
    v_add_f32_dpp v32, v62, v62 row_shl:4 row_mask:0xf bank_mask:0x5
    s_nop 1
    v_add_f32_dpp v32, v62, v62 row_shr:4 row_mask:0xf bank_mask:0xa
    v_add_f32_dpp v63, v56, v56 row_shl:4 row_mask:0xf bank_mask:0x5
    s_nop 1
    v_add_f32_dpp v63, v56, v56 row_shr:4 row_mask:0xf bank_mask:0xa
    v_rcp_f32 v32, v32
    s_nop 0
    v_mul_f32 v63, v63, v32
    v_cvt_pk_bf16_f32 v56, v63, v63
    s_nop 1
    v_and_b32_dpp v96, v56, v8 quad_perm:[0,0,0,0] row_mask:0xf bank_mask:0xf
    v_and_b32_dpp v97, v56, v9 quad_perm:[0,0,0,0] row_mask:0xf bank_mask:0xf
    v_and_b32_dpp v98, v56, v10 quad_perm:[0,0,0,0] row_mask:0xf bank_mask:0xf
    v_and_b32_dpp v99, v56, v11 quad_perm:[0,0,0,0] row_mask:0xf bank_mask:0xf
    v_and_b32_dpp v100, v56, v8 quad_perm:[1,1,1,1] row_mask:0xf bank_mask:0xf
    v_and_b32_dpp v101, v56, v9 quad_perm:[1,1,1,1] row_mask:0xf bank_mask:0xf
    v_and_b32_dpp v102, v56, v10 quad_perm:[1,1,1,1] row_mask:0xf bank_mask:0xf
    v_and_b32_dpp v103, v56, v11 quad_perm:[1,1,1,1] row_mask:0xf bank_mask:0xf
    v_and_b32_dpp v104, v56, v8 quad_perm:[2,2,2,2] row_mask:0xf bank_mask:0xf
    v_and_b32_dpp v105, v56, v9 quad_perm:[2,2,2,2] row_mask:0xf bank_mask:0xf
    v_and_b32_dpp v106, v56, v10 quad_perm:[2,2,2,2] row_mask:0xf bank_mask:0xf
    v_and_b32_dpp v107, v56, v11 quad_perm:[2,2,2,2] row_mask:0xf bank_mask:0xf
    v_and_b32_dpp v108, v56, v8 quad_perm:[3,3,3,3] row_mask:0xf bank_mask:0xf
    v_and_b32_dpp v109, v56, v9 quad_perm:[3,3,3,3] row_mask:0xf bank_mask:0xf
    v_and_b32_dpp v110, v56, v10 quad_perm:[3,3,3,3] row_mask:0xf bank_mask:0xf
    v_and_b32_dpp v111, v56, v11 quad_perm:[3,3,3,3] row_mask:0xf bank_mask:0xf
    s_waitcnt vmcnt(1)
    v_mfma_f32_16x16x32_bf16 v[128:131], v[96:99], v[64:67], 0
    v_mfma_f32_16x16x32_bf16 v[132:135], v[100:103], v[64:67], 0
    s_waitcnt vmcnt(0)
    v_mfma_f32_16x16x32_bf16 v[128:131], v[104:107], v[68:71], v[128:131]
    v_mfma_f32_16x16x32_bf16 v[132:135], v[108:111], v[68:71], v[132:135]
    s_nop 7
    v_add_f32_dpp v128, v132, v128 row_ror:8 row_mask:0xf bank_mask:0xf
    v_add_f32_dpp v129, v133, v129 row_ror:8 row_mask:0xf bank_mask:0xf
    v_add_f32_dpp v130, v134, v130 row_ror:8 row_mask:0xf bank_mask:0xf
    v_add_f32_dpp v131, v135, v131 row_ror:8 row_mask:0xf bank_mask:0xf
    ds_write_b128 v21, v[128:131] offset:1024
    s_mov_b64 exec, 1
    ds_add_rtn_u32 v18, v17, v16 offset:16
    s_mov_b64 exec, -1
    ds_read_b128 v[32:35], v22 offset:1024
    ds_read_b128 v[36:39], v22 offset:9216
    ds_read_b128 v[40:43], v22 offset:17408
    ds_read_b128 v[44:47], v22 offset:25600
    s_waitcnt lgkmcnt(4)
    v_readfirstlane_b32 s62, v18
    s_cmp_lg_u32 s62, 3
    s_cbranch_scc1 L_wpub_38
    s_waitcnt lgkmcnt(2)
    v_pk_add_f32 v[32:33], v[32:33], v[36:37]
    v_pk_add_f32 v[34:35], v[34:35], v[38:39]
    s_waitcnt lgkmcnt(0)
    v_pk_add_f32 v[40:41], v[40:41], v[44:45]
    v_pk_add_f32 v[42:43], v[42:43], v[46:47]
    v_pk_add_f32 v[32:33], v[32:33], v[40:41]
    v_pk_add_f32 v[34:35], v[34:35], v[42:43]
    v_bfi_b32 v32, v6, s50, v32
    v_bfi_b32 v33, v6, s51, v33
    v_bfi_b32 v34, v6, s52, v34
    v_bfi_b32 v35, v6, s53, v35
    buffer_store_dwordx4 v[32:35], v15, s[32:35], s58 offen offset:0 sc1
    s_nop 1
L_wpub_38:
    s_cmp_lt_u32 s44, 2
    s_cbranch_scc1 L_adone_33
    s_cmp_ge_u32 s42, 144
    s_cbranch_scc1 L_adone_33
    v_lshlrev_b32 v148, 2, v1
    s_cmp_eq_u32 s44, 3
    s_cbranch_scc1 L_fred_39
    s_mov_b64 s[84:85], -1
    s_mov_b64 s[86:87], -1
L_lw_42:
    ds_read_b32 v18, v17 offset:20
    s_sub_u32 s63, s63, 1
    s_cbranch_scc1 L_end
    s_sleep 1
    s_waitcnt lgkmcnt(0)
    v_readfirstlane_b32 s62, v18
    s_cmp_lt_u32 s62, 5
    s_cbranch_scc1 L_lw_42
    s_mov_b64 exec, s[84:85]
    buffer_load_dwordx4 v[96:99], v151, s[32:35], s3 offen sc1
    s_mov_b64 exec, s[86:87]
    buffer_load_dwordx4 v[100:103], v151, s[32:35], s4 offen sc1
    s_mov_b64 exec, -1
    s_mov_b64 exec, s[84:85]
    s_waitcnt vmcnt(1)
    v_xor_b32 v96, s50, v96
    v_xor_b32 v97, s51, v97
    v_xor_b32 v98, s52, v98
    v_xor_b32 v99, s53, v99
    v_or3_b32 v32, v96, v97, v98
    v_bitop3_b32 v32, v32, v99, v6 bitop3:0xa8
    v_cmp_ne_u32 s[84:85], 0, v32
    s_mov_b64 exec, s[86:87]
    s_waitcnt vmcnt(0)
    v_xor_b32 v100, s50, v100
    v_xor_b32 v101, s51, v101
    v_xor_b32 v102, s52, v102
    v_xor_b32 v103, s53, v103
    v_or3_b32 v32, v100, v101, v102
    v_bitop3_b32 v32, v32, v103, v6 bitop3:0xa8
    v_cmp_ne_u32 s[86:87], 0, v32
    s_mov_b64 exec, -1
    s_or_b64 vcc, s[84:85], s[86:87]
    s_cbranch_scc1 L_s_again_41
L_s_chk_40:
    v_pk_add_f32 v[96:97], v[96:97], v[100:101]
    v_pk_add_f32 v[98:99], v[98:99], v[102:103]
    s_nop 0
    v_permlane32_swap_b32 v96, v97
    v_permlane32_swap_b32 v98, v99
    v_add_f32 v96, v96, v97
    v_add_f32 v98, v98, v99
    s_nop 1
    v_permlane16_swap_b32 v96, v98
    v_add_f32 v96, v96, v98
    s_nop 1
    v_add_f32_dpp v96, v96, v96 quad_perm:[2,3,0,1] row_mask:0xf bank_mask:0xf
    s_nop 1
    v_add_f32_dpp v96, v96, v96 row_ror:4 row_mask:0xf bank_mask:0xf
    s_nop 1
    v_add_f32_dpp v96, v96, v96 row_ror:8 row_mask:0xf bank_mask:0xf
    v_cvt_pk_bf16_f32 v96, 0, v96
    ds_write_b32 v148, v96 offset:768
    s_mov_b64 exec, 1
    ds_add_u32 v17, v16 offset:28
    s_mov_b64 exec, -1
    s_branch L_adone_33
L_fred_39:
    v_lshlrev_b32 v154, 16, v154
    s_mov_b32 s60, 0x3e800000
    s_mov_b64 s[84:85], -1
    s_mov_b64 s[86:87], -1
    v_mov_b32 v112, 0
    v_mov_b32 v113, 0
    v_mov_b32 v114, 0
    v_mov_b32 v115, 0
    s_mov_b32 s88, 0xffff
    s_mov_b32 s89, 0x0
L_lw_45:
    ds_read_b32 v18, v17 offset:20
    s_sub_u32 s63, s63, 1
    s_cbranch_scc1 L_end
    s_waitcnt lgkmcnt(0)
    v_readfirstlane_b32 s62, v18
    s_cmp_lt_u32 s62, 5
    s_cbranch_scc1 L_lw_45
    s_mov_b64 exec, s[84:85]
    buffer_load_dwordx4 v[104:107], v151, s[32:35], s5 offen sc1
    s_mov_b64 exec, s[86:87]
    buffer_load_dwordx4 v[108:111], v151, s[32:35], s18 offen sc1
    s_mov_b64 exec, s[88:89]
    buffer_load_dwordx4 v[112:115], v151, s[32:35], s19 offen sc1
    s_mov_b64 exec, -1
    s_mov_b64 exec, s[84:85]
    s_waitcnt vmcnt(2)
    v_xor_b32 v104, s50, v104
    v_xor_b32 v105, s51, v105
    v_xor_b32 v106, s52, v106
    v_xor_b32 v107, s53, v107
    v_or3_b32 v32, v104, v105, v106
    v_bitop3_b32 v32, v32, v107, v6 bitop3:0xa8
    v_cmp_ne_u32 s[84:85], 0, v32
    s_mov_b64 exec, s[86:87]
    s_waitcnt vmcnt(1)
    v_xor_b32 v108, s50, v108
    v_xor_b32 v109, s51, v109
    v_xor_b32 v110, s52, v110
    v_xor_b32 v111, s53, v111
    v_or3_b32 v32, v108, v109, v110
    v_bitop3_b32 v32, v32, v111, v6 bitop3:0xa8
    v_cmp_ne_u32 s[86:87], 0, v32
    s_mov_b64 exec, s[88:89]
    s_waitcnt vmcnt(0)
    v_xor_b32 v112, s50, v112
    v_xor_b32 v113, s51, v113
    v_xor_b32 v114, s52, v114
    v_xor_b32 v115, s53, v115
    v_or3_b32 v32, v112, v113, v114
    v_bitop3_b32 v32, v32, v115, v6 bitop3:0xa8
    v_cmp_ne_u32 s[88:89], 0, v32
    s_mov_b64 exec, -1
    s_or_b64 vcc, s[84:85], s[86:87]
    s_or_b64 vcc, vcc, s[88:89]
    s_cbranch_scc1 L_r_again_44
L_r_chk_43:
    ds_read_b32 v18, v17 offset:28
    ds_read_b32 v96, v148 offset:768
    v_pk_add_f32 v[104:105], v[104:105], v[112:113]
    v_pk_add_f32 v[106:107], v[106:107], v[114:115]
    v_pk_add_f32 v[104:105], v[104:105], v[108:109]
    v_pk_add_f32 v[106:107], v[106:107], v[110:111]
    s_nop 0
    v_permlane32_swap_b32 v104, v105
    v_permlane32_swap_b32 v106, v107
    v_add_f32 v104, v104, v105
    v_add_f32 v106, v106, v107
    s_nop 1
    v_permlane16_swap_b32 v104, v106
    v_add_f32 v104, v104, v106
    s_nop 1
    v_add_f32_dpp v104, v104, v104 quad_perm:[2,3,0,1] row_mask:0xf bank_mask:0xf
    s_nop 1
    v_add_f32_dpp v104, v104, v104 row_ror:4 row_mask:0xf bank_mask:0xf
    s_nop 1
    v_add_f32_dpp v104, v104, v104 row_ror:8 row_mask:0xf bank_mask:0xf
    v_cvt_pk_bf16_f32 v104, 0, v104
    v_mul_f32 v32, 0xbfb8aa3b, v104
    v_exp_f32 v32, v32
    s_nop 0
    v_add_f32 v32, 1.0, v32
    v_rcp_f32 v32, v32
    s_nop 0
    v_mul_f32 v32, v32, v104
    v_cvt_pk_bf16_f32 v32, 0, v32
    s_waitcnt lgkmcnt(0)
    v_readfirstlane_b32 s62, v18
    s_cmp_ge_u32 s62, 1
    s_cbranch_scc1 L_haves_46
    s_nop 2
L_lw_47:
    ds_read_b32 v18, v17 offset:28
    ds_read_b32 v96, v148 offset:768
    s_sub_u32 s63, s63, 1
    s_cbranch_scc1 L_end
    s_waitcnt lgkmcnt(0)
    v_readfirstlane_b32 s62, v18
    s_cmp_lt_u32 s62, 1
    s_cbranch_scc1 L_lw_47
L_haves_46:
    s_cmp_lg_u32 s56, 0
    v_mul_f32 v32, v32, v96
    v_cvt_pk_bf16_f32 v32, 0, v32
    v_add_f32 v32, v32, v154
    v_cvt_pk_bf16_f32 v32, v32, v32
    buffer_store_short v32, v153, s[36:39], 0 offen
    s_cbranch_scc1 L_adone_33
    v_mov_b32 v33, s49
    buffer_store_dword v33, v17, s[32:35], 0 offen offset:0
    s_nop 0
L_adone_33:
    s_endpgm
L_q_again_29:
    buffer_load_dwordx4 v[56:59], v20, s[32:35], s66 offen sc1
    buffer_load_dwordx4 v[60:63], v20, s[32:35], s67 offen sc1
    s_sub_u32 s63, s63, 1
    s_cbranch_scc0 L_q_chk_28
    s_endpgm
L_o_again_37:
    buffer_load_dwordx4 v[60:63], v54, s[32:35], s54 offen sc1
    s_waitcnt vmcnt(0)
    s_sub_u32 s63, s63, 1
    s_cbranch_scc0 L_o_chk_36
    s_endpgm
L_s_again_41:
    s_mov_b64 exec, s[84:85]
    s_cbranch_execz L_ms_48
    buffer_load_dwordx4 v[96:99], v151, s[32:35], s3 offen sc1
L_ms_48:
    s_mov_b64 exec, s[86:87]
    s_cbranch_execz L_ms_49
    buffer_load_dwordx4 v[100:103], v151, s[32:35], s4 offen sc1
L_ms_49:
    s_mov_b64 exec, -1
    s_sub_u32 s63, s63, 1
    s_cbranch_scc1 L_end
    s_waitcnt vmcnt(0)
    s_mov_b64 exec, s[84:85]
    s_cbranch_execz L_mz_50
    v_xor_b32 v96, s50, v96
    v_xor_b32 v97, s51, v97
    v_xor_b32 v98, s52, v98
    v_xor_b32 v99, s53, v99
    v_or3_b32 v32, v96, v97, v98
    v_bitop3_b32 v32, v32, v99, v6 bitop3:0xa8
    v_cmp_ne_u32 s[84:85], 0, v32
L_mz_50:
    s_mov_b64 exec, s[86:87]
    s_cbranch_execz L_mz_51
    v_xor_b32 v100, s50, v100
    v_xor_b32 v101, s51, v101
    v_xor_b32 v102, s52, v102
    v_xor_b32 v103, s53, v103
    v_or3_b32 v32, v100, v101, v102
    v_bitop3_b32 v32, v32, v103, v6 bitop3:0xa8
    v_cmp_ne_u32 s[86:87], 0, v32
L_mz_51:
    s_mov_b64 exec, -1
    s_or_b64 vcc, s[84:85], s[86:87]
    s_cbranch_scc1 L_s_again_41
    s_branch L_s_chk_40
L_r_again_44:
    s_mov_b64 exec, s[84:85]
    s_cbranch_execz L_ms_52
    buffer_load_dwordx4 v[104:107], v151, s[32:35], s5 offen sc1
L_ms_52:
    s_mov_b64 exec, s[86:87]
    s_cbranch_execz L_ms_53
    buffer_load_dwordx4 v[108:111], v151, s[32:35], s18 offen sc1
L_ms_53:
    s_mov_b64 exec, s[88:89]
    s_cbranch_execz L_ms_54
    buffer_load_dwordx4 v[112:115], v151, s[32:35], s19 offen sc1
L_ms_54:
    s_mov_b64 exec, -1
    s_sub_u32 s63, s63, 1
    s_cbranch_scc1 L_end
    s_waitcnt vmcnt(0)
    s_mov_b64 exec, s[84:85]
    s_cbranch_execz L_mz_55
    v_xor_b32 v104, s50, v104
    v_xor_b32 v105, s51, v105
    v_xor_b32 v106, s52, v106
    v_xor_b32 v107, s53, v107
    v_or3_b32 v32, v104, v105, v106
    v_bitop3_b32 v32, v32, v107, v6 bitop3:0xa8
    v_cmp_ne_u32 s[84:85], 0, v32
L_mz_55:
    s_mov_b64 exec, s[86:87]
    s_cbranch_execz L_mz_56
    v_xor_b32 v108, s50, v108
    v_xor_b32 v109, s51, v109
    v_xor_b32 v110, s52, v110
    v_xor_b32 v111, s53, v111
    v_or3_b32 v32, v108, v109, v110
    v_bitop3_b32 v32, v32, v111, v6 bitop3:0xa8
    v_cmp_ne_u32 s[86:87], 0, v32
L_mz_56:
    s_mov_b64 exec, s[88:89]
    s_cbranch_execz L_mz_57
    v_xor_b32 v112, s50, v112
    v_xor_b32 v113, s51, v113
    v_xor_b32 v114, s52, v114
    v_xor_b32 v115, s53, v115
    v_or3_b32 v32, v112, v113, v114
    v_bitop3_b32 v32, v32, v115, v6 bitop3:0xa8
    v_cmp_ne_u32 s[88:89], 0, v32
L_mz_57:
    s_mov_b64 exec, -1
    s_or_b64 vcc, s[84:85], s[86:87]
    s_or_b64 vcc, vcc, s[88:89]
    s_cbranch_scc1 L_r_again_44
    s_branch L_r_chk_43
L_end:
    s_endpgm
.p2align 2
.type L_roles,@object
L_roles:
.long 0x21f1d, 0xc04a15, 0x180ba22, 0x844f2b, 0x1405a36, 0x3c07c3e, 0x2828c80, 0x3409c02
.long 0xaaa92, 0xcb3f1b, 0x188bea4, 0x8a5d29, 0x14b6f35, 0x3c86c3c, 0x28bfc81, 0x3490e00
.long 0x122e91, 0xd3ba18, 0x192bca3, 0x91caac, 0x150fd36, 0x3d16a3f, 0x2937b00, 0x3530c01
.long 0x1aae93, 0xdbbc04, 0x1984e23, 0x9c4b2a, 0x15b5c35, 0x3d96cbd, 0x29a8f01, 0x3588e09
.long 0x232c96, 0xe3ae03, 0x1a14ea5, 0xa44cad, 0x163db43, 0x3e0ecbb, 0x2a27a8d, 0x3601c07
.long 0x2b2b13, 0xebad1c, 0x1aabe24, 0xabccae, 0x168db37, 0x3ea6ec0, 0x2a98b02, 0x3689e05
.long 0x31ad17, 0xf0aa1b, 0x1b03e26, 0xb24b2c, 0x1735e38, 0x3f11c3b, 0x2b3fa85, 0x3708a0b
.long 0x3b9e94, 0xfbaa14, 0x1b8ca25, 0xbadf2e, 0x1785f38, 0x3f97cb9, 0x2bafc82, 0x3791f0b
.long 0x441f14, 0x1042e16, 0x1c0cea6, 0x241dd28, 0x3015e39, 0x400ea40, 0x2c47e83, 0x3838a0a
.long 0x4b1d15, 0x10c3e1d, 0x1ca3e27, 0x249daaf, 0x30c5f39, 0x40aea41, 0x2ca0b03, 0x38b0a0c
.long 0x52ad18, 0x1142a19, 0x1d23ca7, 0x251df2f, 0x3145c37, 0x4126a42, 0x2d1fe87, 0x3940b09
.long 0x5c2c9b, 0x1192d20, 0x1d84caa, 0x25accb0, 0x318dd3b, 0x41aeec2, 0x2da8b06, 0x39b0e08
.long 0x621c9c, 0x1202e1e, 0x1e1ba2e, 0x263cb2d, 0x3205d3e, 0x420fec1, 0x2e18f07, 0x3a00e0d
.long 0x6a2d1a, 0x12c3a1f, 0x1e9bc28, 0x26b6b30, 0x32bde3a, 0x4289abf, 0x2eafa8b, 0x3ab8f0a
.long 0x741d16, 0x1312f1f, 0x1f13aa8, 0x2724cb1, 0x330df3c, 0x4316e43, 0x2f20e84, 0x3b38c10
.long 0x7a9a97, 0x1382a20, 0x1f8bc29, 0x27a5b31, 0x33beb3a, 0x43aecbe, 0x2fb7f04, 0x3bb9c0e
.long 0x7fa2a98, 0x7fb3a21, 0x2014aa9, 0x7f9ccb2, 0x7fc5a34, 0x4407a44, 0x7f9fd05, 0x7fc0f0c
.long 0x7f9aaa0, 0x7f8af21, 0x20aba30, 0x7fbceb5, 0x7fbdd3f, 0x4487ec3, 0x7fa7e86, 0x7fb1b0d
.long 0x7fb9a9f, 0x7f93f25, 0x2103c2a, 0x7fadb32, 0x7f97b44, 0x4501aba, 0x7fa0c88, 0x7fc1b0e
.long 0x7fa1a99, 0x7f92b22, 0x21a3a2d, 0x7faceb3, 0x7f95d42, 0x4586abc, 0x7f98c8c, 0x7f91a0f
.long 0x7f9af19, 0x7fc3c1c, 0x2217e2b, 0x7f9ceb8, 0x7fb6d45, 0x460fa45, 0x7fbfe89, 0x7f80d0f
.long 0x7f99aa1, 0x7fb3d27, 0x2294c33, 0x7fb4b33, 0x7fc6e3d, 0x469ecc5, 0x7fb7c8a, 0x7f90a13
.long 0x7fa9c9a, 0x7fbbe1a, 0x231be31, 0x7fbecb4, 0x7fc6d46, 0x4726cc4, 0x7fc7d08, 0x7f81f10
.long 0x7fb1e9e, 0x7fb2f23, 0x2383aab, 0x7fa5eb6, 0x7fbee17, 0x479ee46, 0x7fa7c8e, 0x7f90d12
.long 0x7f99e9d, 0x7f8cd24, 0x7faca2c, 0x7fb4f34, 0x7f95b3d, 0x7f8eec6, 0x7fc7a8f, 0x7f88c11
.long 0x7f99d1e, 0x7f82c06, 0x7fadc32, 0x7fa4f40, 0x7fc6b41, 0x7f86e47, 0x7fafe90, 0x7fc0c12
.long 0x7fa9ea2, 0x7f8ad26, 0x7f93c2f, 0x7fb4cb7, 0x7fb5b47, 0x7f9eac7, 0x7f9fa95, 0x7f80b11
.long 0x7f81000, 0x7f82000, 0x7f83000, 0x7f84000, 0x7f85000, 0x7f86000, 0x7f87000, 0x7f80000
.long 0x7f81200, 0x7f82200, 0x7f83200, 0x7f84200, 0x7f85200, 0x7f86200, 0x7f87200, 0x7f80200
.long 0x7f81400, 0x7f82400, 0x7f83400, 0x7f84400, 0x7f85400, 0x7f86400, 0x7f87400, 0x7f80400
.long 0x7f81600, 0x7f82600, 0x7f83600, 0x7f84600, 0x7f85600, 0x7f86600, 0x7f87600, 0x7f80600
.long 0x7f81800, 0x7f82800, 0x7f83800, 0x7f84800, 0x7f85800, 0x7f86800, 0x7f87800, 0x7f80800
.size L_roles, 1024
L_code_end:
.section .rodata,"a"
.p2align 6
.amdhsa_kernel recurrent_scan__sliding_block_cached__geglu_ffn__decode_kernel
  .amdhsa_next_free_vgpr 168
  .amdhsa_next_free_sgpr 102
  .amdhsa_accum_offset 168
  .amdhsa_group_segment_fixed_size 0
  .amdhsa_kernarg_size 96
  .amdhsa_user_sgpr_count 2
  .amdhsa_user_sgpr_kernarg_segment_ptr 1
  .amdhsa_system_sgpr_workgroup_id_x 1
.end_amdhsa_kernel
```
